```python
import torch

def _softmax(x, axis=-1):
    return torch.softmax(x, dim=axis)
def _gelu(x):
    return torch.nn.functional.gelu(x, approximate="tanh")
def _silu(x):
    return torch.nn.functional.silu(x)
def _sigmoid(x):
    return torch.sigmoid(x)
def _layernorm(x, axis=-1, eps=1e-5):
    m = x.mean(dim=axis, keepdim=True)
    v = x.var(dim=axis, keepdim=True, unbiased=False)
    return (x - m) / torch.sqrt(v + eps)
def _scatter_add(tgt, idx, src, axis=0):
    return tgt.clone().index_add_(axis, idx, src)
def _segment_sum(src, seg, n):
    out = torch.zeros((n,) + src.shape[1:], dtype=src.dtype)
    return out.index_add_(0, seg, src)
def _pad(x, pw):
    flat = tuple(v for pair in reversed(pw) for v in pair)
    return torch.nn.functional.pad(x, flat)

kernel_name = 'parallel_sum__ssm_conv_h3__geglu_ffn__prompt'

def setup_inputs():

    _w = (lambda a: (lambda t: t.to(torch.bfloat16) if t.is_floating_point() else t)(torch.as_tensor(a)))
    def _A_setup():
        B, S, D = 1, 2048, 512
        ks = 4
        return {
            "q": _w((lambda *s: torch.randn(*s, dtype=torch.bfloat16) * 0.05)(B, S, D)),
            "k": _w((lambda *s: torch.randn(*s, dtype=torch.bfloat16) * 0.8)(B, S, D)),
            "v": _w((lambda *s: torch.randn(*s, dtype=torch.bfloat16) * 0.8)(B, S, D)),
            "shift_k": _w((lambda *s: torch.randn(*s, dtype=torch.bfloat16) * 0.8)(D, ks) * 0.5),
            "ssm_k": _w((lambda *s: torch.randn(*s, dtype=torch.bfloat16) * 0.8)(D, S) * (1.0 / S ** 0.5)),
            "ssm_D": _w((lambda *s: torch.randn(*s, dtype=torch.bfloat16) * 0.8)(D)),
        }
    _A_in = _A_setup()

    def _B_setup():
        B, S, D, F = 1, 2048, 512, 1376
        return {
            "x": _w((lambda *s: torch.randn(*s, dtype=torch.bfloat16) * 0.05)(B, S, D)),
            "w_gate": _w((lambda *s: torch.randn(*s, dtype=torch.bfloat16) * 0.05)(D, F)),
            "w_up": _w((lambda *s: torch.randn(*s, dtype=torch.bfloat16) * 0.05)(D, F)),
            "w_down": _w((lambda *s: torch.randn(*s, dtype=torch.bfloat16) * 0.05)(F, D)),
        }
    _B_in = _B_setup()

    return {
        "A_q": _A_in["q"],
        "A_k": _A_in["k"],
        "A_v": _A_in["v"],
        "A_shift_k": _A_in["shift_k"],
        "A_ssm_k": _A_in["ssm_k"],
        "A_ssm_D": _A_in["ssm_D"],
        "B_x": _B_in["x"],
        "B_w_gate": _B_in["w_gate"],
        "B_w_up": _B_in["w_up"],
        "B_w_down": _B_in["w_down"],
    }

def reference(A_q, A_k, A_v, A_shift_k, A_ssm_k, A_ssm_D, B_x, B_w_gate, B_w_up, B_w_down):
    def _A_ref(q, k, v, shift_k, ssm_k, ssm_D):
        B, S, D = q.shape
        ks = shift_k.shape[-1]
        k_pad = _pad(k, ((0, 0), (ks - 1, 0), (0, 0)))
        k_shift = torch.zeros_like(k)
        for t in range(ks):
            k_shift = k_shift + k_pad[:, t:t + S, :] * shift_k[:, ks - 1 - t][None, None, :]
        kv = k_shift * v
        L = 2 * S
        kv_pad = _pad(kv, ((0, 0), (0, S), (0, 0)))
        kf_pad = _pad(ssm_k, ((0, 0), (0, S)))
        kv_f = (lambda x, axes=(-2,-1): torch.fft.rfft2(x.float(), dim=axes))(kv_pad[:, None, :, :], axes=(1, 2))
        kf_f = (lambda x, axes=(-2,-1): torch.fft.rfft2(x.float(), dim=axes))(kf_pad[:, None, :], axes=(1, 2))
        kf_f = (lambda x, *d: x.permute(*d))(kf_f, 1, 2, 0)
        y_f = kv_f * kf_f[None, :, :, :]
        y = (lambda x, s, axes=(-2,-1): torch.fft.irfft2(x, s=s, dim=axes).to(torch.bfloat16))(y_f, (1, L), axes=(1, 2))[:, 0, :S, :]
        y = y + kv * ssm_D[None, None, :]
        return q * y

    def _B_ref(x, w_gate, w_up, w_down):
        return (_gelu(x @ w_gate) * (x @ w_up)) @ w_down

    x = A_q
    xn = _layernorm(x, axis=-1)
    return x + _A_ref(xn, A_k, A_v, A_shift_k, A_ssm_k, A_ssm_D) + _B_ref(xn, B_w_gate, B_w_up, B_w_down)
```

```asm
; @launch grid=(256,1,1) block=(512,1,1) lds=163840
.amdgcn_target "amdgcn-amd-amdhsa--gfx950"
.text
    .globl parallel_sum__ssm_conv_h3__geglu_ffn__prompt_kernel
    .p2align 8
    .type parallel_sum__ssm_conv_h3__geglu_ffn__prompt_kernel,@function
parallel_sum__ssm_conv_h3__geglu_ffn__prompt_kernel:
    s_cmp_ge_u32 s2, 256
    s_cbranch_scc1 L_end
    v_lshrrev_b32 v1, 6, v0
    s_load_dwordx2 s[4:5], s[0:1], 0
    s_load_dwordx2 s[16:17], s[0:1], 96
    v_readfirstlane_b32 s48, v1
    v_and_b32 v0, 63, v0
    s_cmp_ge_u32 s48, 6
    s_cbranch_scc1 L_help
    s_cmp_ge_u32 s48, 4
    s_cbranch_scc1 L_load
    s_load_dwordx2 s[8:9], s[0:1], 56
    s_load_dwordx2 s[12:13], s[0:1], 64
    v_mov_b32 v20, 0
    v_lshlrev_b32 v5, 2, v0
    v_add_u32 v5, 138752, v5
    ds_write_b32 v5, v20
    s_mov_b32 s6, 0x200000
    s_mov_b32 s7, 0x20000
    s_mov_b32 s10, 0x158000
    s_mov_b32 s11, 0x20000
    s_mov_b32 s14, 0x158000
    s_mov_b32 s15, 0x20000
    s_and_b32 s53, s2, 1
    s_lshl_b32 s53, s53, 3
    s_bfe_u32 s54, s2, 0x30003
    s_add_u32 s49, s53, s54
    s_bfe_u32 s53, s2, 0x20001
    s_lshl_b32 s53, s53, 2
    s_lshr_b32 s55, s2, 6
    s_add_u32 s50, s53, s55
    s_mov_b32 s46, 0xd951c840
    s_mov_b32 s47, 0xea62fb73
    s_lshl_b32 s50, s50, 2
    s_lshr_b64 s[46:47], s[46:47], s50
    s_and_b32 s50, s46, 15
    s_mul_i32 s51, s50, 3
    s_lshr_b32 s53, s50, 2
    s_sub_u32 s51, s51, s53
    s_cmp_eq_u32 s50, 15
    s_subb_u32 s51, s51, 0
    s_bitcmp1_b32 0xc888, s50
    s_cselect_b32 s52, 2, 3
    s_and_b32 s64, s48, 3
    s_and_b32 s53, s48, 1
    s_lshl_b32 s53, s53, 2
    v_lshrrev_b32 v5, 4, v0
    v_add_u32 v5, s53, v5
    v_and_b32 v6, 7, v0
    v_xor_b32 v5, v5, v6
    v_lshlrev_b32 v5, 4, v5
    v_lshrrev_b32 v6, 3, v0
    v_lshl_add_u32 v14, v6, 10, v5
    v_lshrrev_b32 v5, 5, v0
    v_lshlrev_b32 v5, 1, v5
    v_and_b32 v6, 3, v0
    v_xor_b32 v5, v5, v6
    v_lshlrev_b32 v5, 4, v5
    v_lshrrev_b32 v6, 2, v0
    v_mul_u32_u24 v6, 2752, v6
    v_add_u32 v15, v6, v5
    s_lshl_b32 s60, s49, 17
    s_lshl_b32 s53, s64, 13
    s_add_u32 s60, s60, s53
    s_mul_i32 s61, s64, 44032
    s_lshl_b32 s53, s51, 6
    s_add_u32 s61, s61, s53
    s_cmp_eq_u32 s52, 3
    s_cselect_b32 s62, s61, 0x7f000000
    s_lshl_b32 s63, s64, 10
    s_waitcnt lgkmcnt(0)
    s_setprio 3
    s_add_u32 m0, s63, 0
    s_nop 0
    buffer_load_dwordx4 v14, s[4:7], s60 offen  lds
    s_add_u32 m0, s63, 4096
    s_add_u32 s60, s60, 32768
    buffer_load_dwordx4 v14, s[4:7], s60 offen  lds
    s_add_u32 m0, s63, 8192
    s_add_u32 s60, s60, 32768
    buffer_load_dwordx4 v14, s[4:7], s60 offen  lds
    s_add_u32 m0, s63, 12288
    s_add_u32 s60, s60, 32768
    buffer_load_dwordx4 v14, s[4:7], s60 offen  lds
    s_add_u32 m0, s63, 16384
    s_nop 0
    buffer_load_dwordx4 v15, s[8:11], s61 offen offset:0  lds
    s_add_u32 m0, s63, 28672
    s_nop 0
    buffer_load_dwordx4 v15, s[12:15], s61 offen offset:0  lds
    s_add_u32 m0, s63, 20416
    s_nop 0
    buffer_load_dwordx4 v15, s[8:11], s61 offen offset:64  lds
    s_add_u32 m0, s63, 32704
    s_nop 0
    buffer_load_dwordx4 v15, s[12:15], s61 offen offset:64  lds
    s_add_u32 m0, s63, 24448
    s_nop 0
    buffer_load_dwordx4 v15, s[8:11], s62 offen offset:128  lds
    s_add_u32 m0, s63, 36736
    s_nop 0
    buffer_load_dwordx4 v15, s[12:15], s62 offen offset:128  lds
    s_barrier
    s_load_dwordx2 s[20:21], s[0:1], 8
    s_load_dwordx2 s[24:25], s[0:1], 16
    s_load_dwordx2 s[28:29], s[0:1], 24
    s_load_dwordx2 s[32:33], s[0:1], 72
    s_load_dwordx2 s[36:37], s[0:1], 80
    s_load_dwordx2 s[40:41], s[0:1], 32
    s_load_dwordx2 s[44:45], s[0:1], 40
    s_mov_b32 s18, 0x1500000
    s_mov_b32 s19, 0x20000
    s_mov_b32 s22, 0x200000
    s_mov_b32 s23, 0x20000
    s_mov_b32 s26, 0x200000
    s_mov_b32 s27, 0x20000
    s_mov_b32 s30, 0x1000
    s_mov_b32 s31, 0x20000
    s_mov_b32 s34, 0x158000
    s_mov_b32 s35, 0x20000
    s_mov_b32 s38, 0x200000
    s_mov_b32 s39, 0x20000
    s_mov_b32 s42, 0x200000
    s_mov_b32 s43, 0x20000
    s_lshl_b32 s67, s49, 4
    s_add_u32 s67, s67, s50
    s_and_b32 s53, s2, 1
    s_lshl_b32 s53, s53, 4
    s_and_b32 s54, s2, 6
    s_lshl_b32 s54, s54, 1
    s_add_u32 s53, s53, s54
    s_bfe_u32 s54, s2, 0x20003
    s_add_u32 s68, s53, s54
    s_lshr_b32 s69, s2, 5
    s_mov_b32 s75, 0
    s_and_b32 s65, s48, 1
    s_lshr_b32 s66, s48, 1
    v_and_b32 v10, 15, v0
    v_lshrrev_b32 v11, 4, v0
    v_lshrrev_b32 v12, 1, v10
    v_xor_b32 v12, v12, v11
    v_lshlrev_b32 v12, 4, v12
    v_lshl_add_u32 v2, v10, 7, v12
    s_lshl_b32 s53, s65, 13
    v_add_u32 v2, s53, v2
    v_xor_b32 v3, 64, v2
    v_lshlrev_b32 v12, 9, v11
    v_bfe_u32 v13, v0, 2, 2
    v_lshl_add_u32 v12, v13, 6, v12
    v_and_b32 v13, 3, v0
    v_lshl_add_u32 v12, v13, 3, v12
    v_and_b32 v13, 1, v11
    v_lshl_add_u32 v12, v13, 5, v12
    s_mul_i32 s53, s66, s52
    s_add_u32 s54, s53, 0
    s_and_b32 s55, s54, 1
    s_lshl_b32 s55, s55, 5
    s_lshr_b32 s54, s54, 1
    s_lshl_b32 s54, s54, 12
    s_add_u32 s54, s54, 16384
    v_xor_b32 v4, s55, v12
    v_add_u32 v4, s54, v4
    s_add_u32 s54, s53, 1
    s_and_b32 s55, s54, 1
    s_lshl_b32 s55, s55, 5
    s_lshr_b32 s54, s54, 1
    s_lshl_b32 s54, s54, 12
    s_add_u32 s54, s54, 16384
    v_xor_b32 v5, s55, v12
    v_add_u32 v5, s54, v5
    s_add_u32 s54, s53, 2
    s_and_b32 s55, s54, 1
    s_lshl_b32 s55, s55, 5
    s_lshr_b32 s54, s54, 1
    s_lshl_b32 s54, s54, 12
    s_add_u32 s54, s54, 16384
    v_xor_b32 v6, s55, v12
    v_add_u32 v6, s54, v6
    v_lshlrev_b32 v240, 4, v0
    v_lshrrev_b32 v12, 4, v0
    v_lshlrev_b32 v13, 1, v12
    v_and_b32 v14, 7, v0
    v_xor_b32 v13, v13, v14
    v_lshlrev_b32 v13, 4, v13
    v_lshrrev_b32 v14, 3, v0
    v_lshl_add_u32 v241, v14, 10, v13
    s_lshl_b32 s59, s64, 12
    s_lshl_b32 s101, s64, 13
    s_add_u32 s63, s101, 147456
    s_add_u32 s101, s101, 131072
    s_cmp_eq_u32 s64, 0
    s_cselect_b32 s101, 127488, s101
    s_mov_b32 s53, 0
    s_add_u32 s3, s53, 7
    s_sub_u32 s54, s3, 11
    s_cmp_ge_u32 s3, 11
    s_cselect_b32 s3, s54, s3
    s_mul_i32 s74, s64, 360448
    s_lshl_b32 s54, s69, 7
    s_add_u32 s74, s74, s54
    s_mov_b32 s71, s53
    s_cmp_eq_u32 s48, 3
    s_cselect_b32 s72, 10, 99
    v_lshrrev_b32 v13, 2, v0
    v_lshlrev_b32 v13, 7, v13
    v_and_b32 v15, 3, v0
    v_lshl_add_u32 v13, v15, 3, v13
    v_add_u32 v13, s59, v13
    v_and_b32 v14, 3, v14
    s_sub_u32 s54, s101, s59
    v_xor_b32 v15, 0, v14
    v_lshl_add_u32 v242, v15, 5, v13
    v_add_u32 v246, s54, v242
    v_add_u32 v250, 0x10000, v242
    v_xor_b32 v15, 1, v14
    v_lshl_add_u32 v243, v15, 5, v13
    v_add_u32 v247, s54, v243
    v_add_u32 v251, 0x10000, v243
    v_xor_b32 v15, 2, v14
    v_lshl_add_u32 v244, v15, 5, v13
    v_add_u32 v248, s54, v244
    v_add_u32 v252, 0x10000, v244
    v_xor_b32 v15, 3, v14
    v_lshl_add_u32 v245, v15, 5, v13
    v_add_u32 v249, s54, v245
    v_add_u32 v253, 0x10000, v245
    s_mul_i32 s73, s68, 176128
    s_mul_i32 s53, s48, 22528
    s_add_u32 s73, s73, s53
    s_lshl_b32 s53, s68, 2
    s_add_u32 s53, s53, s48
    s_lshl_b32 s53, s53, 10
    s_add_u32 s53, s53, 0xaa0000
    v_and_b32 v12, 15, v0
    v_min_u32 v12, 10, v12
    v_add_u32 v12, s71, v12
    v_subrev_u32 v13, 11, v12
    v_min_u32 v12, v12, v13
    v_bfe_u32 v13, v0, 4, 1
    v_lshl_add_u32 v12, v12, 1, v13
    v_mul_u32_u24 v13, 0x56, v12
    v_lshrrev_b32 v13, 8, v13
    s_cmp_eq_u32 s48, 3
    s_cselect_b32 s54, 2, 3
    v_lshrrev_b32 v12, 1, v12
    v_subrev_u32 v12, s54, v12
    v_max_i32 v12, v12, v13
    v_min_u32 v12, 7, v12
    v_lshlrev_b32 v12, 7, v12
    v_add_u32 v254, s53, v12
    v_and_b32 v10, 15, v0
    v_lshlrev_b32 v10, 4, v10
    s_lshl_b32 s53, s65, 10
    s_add_u32 s53, s53, 136704
    v_add_u32 v208, s53, v10
    s_mul_i32 s54, s66, s52
    s_lshl_b32 s53, s54, 6
    s_add_u32 s53, s53, 135680
    v_and_b32 v11, 48, v0
    v_add_u32 v209, s53, v11
    s_lshl_b32 s53, s49, 1
    s_add_u32 s53, s53, s65
    s_mul_i32 s53, s53, 172
    s_lshl_b32 s55, s51, 1
    s_add_u32 s53, s53, s55
    s_add_u32 s53, s53, s54
    s_lshl_b32 s60, s53, 10
    s_add_u32 s61, s60, 88064
    s_lshl_b32 s53, s65, 2
    s_add_u32 s53, s53, 138752
    v_mov_b32 v15, s53
    v_pk_mov_b32 v[16:17], 0, 0
    v_pk_mov_b32 v[18:19], 0, 0
    v_pk_mov_b32 v[20:21], 0, 0
    v_pk_mov_b32 v[22:23], 0, 0
    v_pk_mov_b32 v[24:25], 0, 0
    v_pk_mov_b32 v[26:27], 0, 0
    v_pk_mov_b32 v[28:29], 0, 0
    v_pk_mov_b32 v[30:31], 0, 0
    v_pk_mov_b32 v[32:33], 0, 0
    v_pk_mov_b32 v[34:35], 0, 0
    v_pk_mov_b32 v[36:37], 0, 0
    v_pk_mov_b32 v[38:39], 0, 0
    v_pk_mov_b32 v[40:41], 0, 0
    v_pk_mov_b32 v[42:43], 0, 0
    v_pk_mov_b32 v[44:45], 0, 0
    v_pk_mov_b32 v[46:47], 0, 0
    v_pk_mov_b32 v[48:49], 0, 0
    v_pk_mov_b32 v[50:51], 0, 0
    v_pk_mov_b32 v[52:53], 0, 0
    v_pk_mov_b32 v[54:55], 0, 0
    v_pk_mov_b32 v[56:57], 0, 0
    v_pk_mov_b32 v[58:59], 0, 0
    v_pk_mov_b32 v[60:61], 0, 0
    v_pk_mov_b32 v[62:63], 0, 0
    v_pk_mov_b32 v[64:65], 0, 0
    v_pk_mov_b32 v[66:67], 0, 0
    v_pk_mov_b32 v[68:69], 0, 0
    v_pk_mov_b32 v[70:71], 0, 0
    v_pk_mov_b32 v[72:73], 0, 0
    v_pk_mov_b32 v[74:75], 0, 0
    v_pk_mov_b32 v[76:77], 0, 0
    v_pk_mov_b32 v[78:79], 0, 0
    v_pk_mov_b32 v[80:81], 0, 0
    v_pk_mov_b32 v[82:83], 0, 0
    v_pk_mov_b32 v[84:85], 0, 0
    v_pk_mov_b32 v[86:87], 0, 0
    v_pk_mov_b32 v[88:89], 0, 0
    v_pk_mov_b32 v[90:91], 0, 0
    v_pk_mov_b32 v[92:93], 0, 0
    v_pk_mov_b32 v[94:95], 0, 0
    v_pk_mov_b32 v[96:97], 0, 0
    v_pk_mov_b32 v[98:99], 0, 0
    v_pk_mov_b32 v[100:101], 0, 0
    v_pk_mov_b32 v[102:103], 0, 0
    v_pk_mov_b32 v[104:105], 0, 0
    v_pk_mov_b32 v[106:107], 0, 0
    v_pk_mov_b32 v[108:109], 0, 0
    v_pk_mov_b32 v[110:111], 0, 0
    v_mov_b32 v7, v2
    v_mov_b32 v8, v3
    v_mov_b32 v9, v4
    v_mov_b32 v10, v5
    v_mov_b32 v11, v6
    s_mov_b32 s57, 0
    s_mov_b32 s58, 0
    v_mov_b32 v12, 138752
    v_mov_b32 v193, 138752
    v_mov_b32 v13, 1
    s_lshl_b32 s53, s48, 2
    s_add_u32 s53, s53, 138768
    v_mov_b32 v194, s53
    s_cmp_eq_u32 s52, 2
    s_cselect_b64 vcc, -1, 0
    s_waitcnt vmcnt(0)
    ds_write_b32 v194, v13 offset:32
lw_1:
    ds_read_b128 v[196:199], v12 offset:48
    s_waitcnt lgkmcnt(0)
    v_min3_u32 v196, v196, v197, v198
    v_min_u32 v196, v196, v199
    s_nop 0
    v_readfirstlane_b32 s53, v196
    s_nop 0
    s_cmp_ge_u32 s53, 1
    s_cbranch_scc1 lw_ok_2
    s_add_u32 s75, s75, 1
    s_cmp_lt_u32 s75, 4194304
    s_cbranch_scc1 lw_1
lw_ok_2:
    ds_read_b128 v[112:115], v7 offset:0
    ds_read_b128 v[116:119], v7 offset:2048
    ds_read_b128 v[120:123], v7 offset:4096
    ds_read_b128 v[124:127], v7 offset:6144
    ds_read_b64_tr_b16 v[128:129], v9 offset:0
    ds_read_b64_tr_b16 v[130:131], v9 offset:256
    ds_read_b64_tr_b16 v[132:133], v9 offset:12288
    ds_read_b64_tr_b16 v[134:135], v9 offset:12544
    ds_read_b64_tr_b16 v[136:137], v10 offset:0
    ds_read_b64_tr_b16 v[138:139], v10 offset:256
    ds_read_b64_tr_b16 v[140:141], v10 offset:12288
    ds_read_b64_tr_b16 v[142:143], v10 offset:12544
    ds_read_b64_tr_b16 v[144:145], v11 offset:0
    ds_read_b64_tr_b16 v[146:147], v11 offset:256
    ds_read_b64_tr_b16 v[148:149], v11 offset:12288
    ds_read_b64_tr_b16 v[150:151], v11 offset:12544
    s_waitcnt lgkmcnt(0)
g1_loop:
    s_add_u32 s58, s58, 40960
    s_cmp_eq_u32 s58, 122880
    s_cselect_b32 s58, 0, s58
    s_add_u32 s57, s57, 1
    s_and_b32 s55, s57, 7
    s_waitcnt lgkmcnt(8)
    ds_read_b128 v[152:155], v8 offset:0
    v_mfma_f32_16x16x32_bf16 v[16:19], v[128:131], v[112:115], v[16:19]
    ds_read_b128 v[156:159], v8 offset:2048
    v_mfma_f32_16x16x32_bf16 v[20:23], v[128:131], v[116:119], v[20:23]
    ds_read_b128 v[160:163], v8 offset:4096
    v_mfma_f32_16x16x32_bf16 v[24:27], v[128:131], v[120:123], v[24:27]
    ds_read_b128 v[164:167], v8 offset:6144
    v_mfma_f32_16x16x32_bf16 v[28:31], v[128:131], v[124:127], v[28:31]
    ds_read_b64_tr_b16 v[168:169], v9 offset:2048
    v_mfma_f32_16x16x32_bf16 v[32:35], v[132:135], v[112:115], v[32:35]
    ds_read_b64_tr_b16 v[170:171], v9 offset:2304
    v_mfma_f32_16x16x32_bf16 v[36:39], v[132:135], v[116:119], v[36:39]
    ds_read_b64_tr_b16 v[172:173], v9 offset:14336
    v_mfma_f32_16x16x32_bf16 v[40:43], v[132:135], v[120:123], v[40:43]
    ds_read_b64_tr_b16 v[174:175], v9 offset:14592
    v_mfma_f32_16x16x32_bf16 v[44:47], v[132:135], v[124:127], v[44:47]
    s_waitcnt lgkmcnt(12)
    ds_read_b32 v192, v193 offset:32
    ds_read_b64_tr_b16 v[176:177], v10 offset:2048
    v_mfma_f32_16x16x32_bf16 v[48:51], v[136:139], v[112:115], v[48:51]
    ds_read_b64_tr_b16 v[178:179], v10 offset:2304
    v_mfma_f32_16x16x32_bf16 v[52:55], v[136:139], v[116:119], v[52:55]
    ds_read_b64_tr_b16 v[180:181], v10 offset:14336
    v_mfma_f32_16x16x32_bf16 v[56:59], v[136:139], v[120:123], v[56:59]
    ds_read_b64_tr_b16 v[182:183], v10 offset:14592
    v_mfma_f32_16x16x32_bf16 v[60:63], v[136:139], v[124:127], v[60:63]
    ds_read_b64_tr_b16 v[184:185], v11 offset:2048
    v_mfma_f32_16x16x32_bf16 v[64:67], v[140:143], v[112:115], v[64:67]
    ds_read_b64_tr_b16 v[186:187], v11 offset:2304
    v_mfma_f32_16x16x32_bf16 v[68:71], v[140:143], v[116:119], v[68:71]
    ds_read_b64_tr_b16 v[188:189], v11 offset:14336
    v_mfma_f32_16x16x32_bf16 v[72:75], v[140:143], v[120:123], v[72:75]
    ds_read_b64_tr_b16 v[190:191], v11 offset:14592
    v_mfma_f32_16x16x32_bf16 v[76:79], v[140:143], v[124:127], v[76:79]
    ds_write_b32 v194, v13
    s_cbranch_vccnz g1_skip_3
    s_waitcnt lgkmcnt(15)
    v_mfma_f32_16x16x32_bf16 v[80:83], v[144:147], v[112:115], v[80:83]
    v_mfma_f32_16x16x32_bf16 v[84:87], v[144:147], v[116:119], v[84:87]
    v_mfma_f32_16x16x32_bf16 v[88:91], v[144:147], v[120:123], v[88:91]
    v_mfma_f32_16x16x32_bf16 v[92:95], v[144:147], v[124:127], v[92:95]
    v_mfma_f32_16x16x32_bf16 v[96:99], v[148:151], v[112:115], v[96:99]
    v_mfma_f32_16x16x32_bf16 v[100:103], v[148:151], v[116:119], v[100:103]
    v_mfma_f32_16x16x32_bf16 v[104:107], v[148:151], v[120:123], v[104:107]
    v_mfma_f32_16x16x32_bf16 v[108:111], v[148:151], v[124:127], v[108:111]
g1_skip_3:
    s_waitcnt lgkmcnt(9)
    v_mfma_f32_16x16x32_bf16 v[16:19], v[168:171], v[152:155], v[16:19]
    v_add_u32 v7, s58, v2
    v_mfma_f32_16x16x32_bf16 v[20:23], v[168:171], v[156:159], v[20:23]
    v_readfirstlane_b32 s53, v192
    v_add_u32 v9, s58, v4
    v_mfma_f32_16x16x32_bf16 v[24:27], v[168:171], v[160:163], v[24:27]
    s_cmp_lt_u32 s53, s55
    s_cbranch_scc1 g1_slow_4
    ds_read_b128 v[112:115], v7 offset:0
    ds_read_b128 v[116:119], v7 offset:2048
    v_add_u32 v10, s58, v5
    v_mfma_f32_16x16x32_bf16 v[28:31], v[168:171], v[164:167], v[28:31]
    ds_read_b128 v[120:123], v7 offset:4096
    ds_read_b128 v[124:127], v7 offset:6144
    v_add_u32 v11, s58, v6
    v_mfma_f32_16x16x32_bf16 v[32:35], v[172:175], v[152:155], v[32:35]
    ds_read_b64_tr_b16 v[128:129], v9 offset:0
    ds_read_b64_tr_b16 v[130:131], v9 offset:256
    v_add_u32 v8, s58, v3
    v_mfma_f32_16x16x32_bf16 v[36:39], v[172:175], v[156:159], v[36:39]
    ds_read_b64_tr_b16 v[132:133], v9 offset:12288
    v_add_u32 v13, 1, v13
    v_mfma_f32_16x16x32_bf16 v[40:43], v[172:175], v[160:163], v[40:43]
    ds_read_b64_tr_b16 v[134:135], v9 offset:12544
    v_xor_b32 v193, 4, v193
    v_mfma_f32_16x16x32_bf16 v[44:47], v[172:175], v[164:167], v[44:47]
    s_waitcnt lgkmcnt(13)
    ds_read_b64_tr_b16 v[136:137], v10 offset:0
    v_mfma_f32_16x16x32_bf16 v[48:51], v[176:179], v[152:155], v[48:51]
    ds_read_b64_tr_b16 v[138:139], v10 offset:256
    v_mfma_f32_16x16x32_bf16 v[52:55], v[176:179], v[156:159], v[52:55]
    ds_read_b64_tr_b16 v[140:141], v10 offset:12288
    v_mfma_f32_16x16x32_bf16 v[56:59], v[176:179], v[160:163], v[56:59]
    ds_read_b64_tr_b16 v[142:143], v10 offset:12544
    v_mfma_f32_16x16x32_bf16 v[60:63], v[176:179], v[164:167], v[60:63]
    ds_read_b64_tr_b16 v[144:145], v11 offset:0
    v_mfma_f32_16x16x32_bf16 v[64:67], v[180:183], v[152:155], v[64:67]
    ds_read_b64_tr_b16 v[146:147], v11 offset:256
    v_mfma_f32_16x16x32_bf16 v[68:71], v[180:183], v[156:159], v[68:71]
    ds_read_b64_tr_b16 v[148:149], v11 offset:12288
    v_mfma_f32_16x16x32_bf16 v[72:75], v[180:183], v[160:163], v[72:75]
    ds_read_b64_tr_b16 v[150:151], v11 offset:12544
    v_mfma_f32_16x16x32_bf16 v[76:79], v[180:183], v[164:167], v[76:79]
    s_cbranch_vccnz g1_skip_5
    s_waitcnt lgkmcnt(15)
    v_mfma_f32_16x16x32_bf16 v[80:83], v[184:187], v[152:155], v[80:83]
    v_mfma_f32_16x16x32_bf16 v[84:87], v[184:187], v[156:159], v[84:87]
    v_mfma_f32_16x16x32_bf16 v[88:91], v[184:187], v[160:163], v[88:91]
    v_mfma_f32_16x16x32_bf16 v[92:95], v[184:187], v[164:167], v[92:95]
    v_mfma_f32_16x16x32_bf16 v[96:99], v[188:191], v[152:155], v[96:99]
    v_mfma_f32_16x16x32_bf16 v[100:103], v[188:191], v[156:159], v[100:103]
    v_mfma_f32_16x16x32_bf16 v[104:107], v[188:191], v[160:163], v[104:107]
    v_mfma_f32_16x16x32_bf16 v[108:111], v[188:191], v[164:167], v[108:111]
g1_skip_5:
    s_cmp_lt_u32 s57, 8
    s_cbranch_scc1 g1_loop
ga_7:
    ds_read_b32 v14, v12 offset:8
    ds_read_b128 v[144:147], v208 offset:0
    ds_read_b128 v[148:151], v208 offset:256
    ds_read_b128 v[152:155], v208 offset:512
    ds_read_b128 v[156:159], v208 offset:768
    ds_read_b128 v[216:219], v209 offset:0
    ds_read_b128 v[220:223], v209 offset:512
    ds_read_b128 v[224:227], v209 offset:64
    ds_read_b128 v[228:231], v209 offset:576
    ds_read_b128 v[232:235], v209 offset:128
    ds_read_b128 v[236:239], v209 offset:640
    ds_read_b32 v1, v12 offset:40
    v_mov_b32 v13, 1
    s_waitcnt lgkmcnt(7)
    v_readfirstlane_b32 s53, v14
    v_mov_b32 v112, v144
    v_mov_b32 v113, v144
    v_mov_b32 v114, v145
    v_mov_b32 v115, v145
    v_mov_b32 v116, v146
    v_mov_b32 v117, v146
    v_mov_b32 v118, v147
    v_mov_b32 v119, v147
    s_cmp_ge_u32 s53, 2
    s_cbranch_scc1 ga_ok_8
    s_add_u32 s75, s75, 1
    s_cmp_lt_u32 s75, 4194304
    s_cbranch_scc1 ga_7
ga_ok_8:
    v_mov_b32 v120, v148
    v_mov_b32 v121, v148
    v_mov_b32 v122, v149
    v_mov_b32 v123, v149
    v_mov_b32 v124, v150
    v_mov_b32 v125, v150
    v_mov_b32 v126, v151
    v_mov_b32 v127, v151
    v_mov_b32 v128, v152
    v_mov_b32 v129, v152
    v_mov_b32 v130, v153
    v_mov_b32 v131, v153
    v_mov_b32 v132, v154
    v_mov_b32 v133, v154
    v_mov_b32 v134, v155
    v_mov_b32 v135, v155
    v_mov_b32 v136, v156
    v_mov_b32 v137, v156
    v_mov_b32 v138, v157
    v_mov_b32 v139, v157
    v_mov_b32 v140, v158
    v_mov_b32 v141, v158
    v_mov_b32 v142, v159
    v_mov_b32 v143, v159
    s_waitcnt lgkmcnt(0)
    v_readfirstlane_b32 s70, v1
    v_pk_fma_f32 v[16:17], v[216:217], v[112:113], v[16:17] neg_lo:[0,1,0] neg_hi:[0,1,0]
    v_pk_fma_f32 v[18:19], v[218:219], v[112:113], v[18:19] neg_lo:[0,1,0] neg_hi:[0,1,0]
    v_pk_fma_f32 v[20:21], v[216:217], v[120:121], v[20:21] neg_lo:[0,1,0] neg_hi:[0,1,0]
    v_pk_fma_f32 v[22:23], v[218:219], v[120:121], v[22:23] neg_lo:[0,1,0] neg_hi:[0,1,0]
    v_pk_mul_f32 v[168:169], v[16:17], v[16:17]
    v_pk_mul_f32 v[176:177], v[18:19], v[18:19]
    v_pk_mul_f32 v[184:185], v[20:21], v[20:21]
    v_pk_mul_f32 v[192:193], v[22:23], v[22:23]
    v_pk_fma_f32 v[168:169], v[168:169], v[116:117], v[114:115]
    v_pk_fma_f32 v[176:177], v[176:177], v[116:117], v[114:115]
    v_pk_fma_f32 v[184:185], v[184:185], v[124:125], v[122:123]
    v_pk_fma_f32 v[192:193], v[192:193], v[124:125], v[122:123]
    v_pk_mul_f32 v[168:169], v[168:169], v[16:17]
    v_pk_mul_f32 v[176:177], v[176:177], v[18:19]
    v_pk_mul_f32 v[184:185], v[184:185], v[20:21]
    v_pk_mul_f32 v[192:193], v[192:193], v[22:23]
    v_exp_f32 v168, v168
    v_exp_f32 v169, v169
    v_exp_f32 v176, v176
    v_exp_f32 v177, v177
    v_exp_f32 v184, v184
    v_exp_f32 v185, v185
    v_exp_f32 v192, v192
    v_exp_f32 v193, v193
    v_pk_fma_f32 v[32:33], v[220:221], v[112:113], v[32:33] neg_lo:[0,1,0] neg_hi:[0,1,0]
    v_pk_fma_f32 v[34:35], v[222:223], v[112:113], v[34:35] neg_lo:[0,1,0] neg_hi:[0,1,0]
    v_pk_fma_f32 v[36:37], v[220:221], v[120:121], v[36:37] neg_lo:[0,1,0] neg_hi:[0,1,0]
    v_pk_fma_f32 v[38:39], v[222:223], v[120:121], v[38:39] neg_lo:[0,1,0] neg_hi:[0,1,0]
    v_pk_fma_f32 v[168:169], v[168:169], v[118:119], v[118:119]
    v_pk_fma_f32 v[176:177], v[176:177], v[118:119], v[118:119]
    v_pk_fma_f32 v[184:185], v[184:185], v[126:127], v[126:127]
    v_pk_fma_f32 v[192:193], v[192:193], v[126:127], v[126:127]
    v_rcp_f32 v168, v168
    v_rcp_f32 v169, v169
    v_rcp_f32 v176, v176
    v_rcp_f32 v177, v177
    v_rcp_f32 v184, v184
    v_rcp_f32 v185, v185
    v_rcp_f32 v192, v192
    v_rcp_f32 v193, v193
    v_pk_mul_f32 v[16:17], v[16:17], v[32:33]
    v_pk_mul_f32 v[18:19], v[18:19], v[34:35]
    v_pk_mul_f32 v[20:21], v[20:21], v[36:37]
    v_pk_mul_f32 v[22:23], v[22:23], v[38:39]
    v_pk_mul_f32 v[168:169], v[168:169], v[16:17]
    v_pk_mul_f32 v[176:177], v[176:177], v[18:19]
    v_pk_mul_f32 v[184:185], v[184:185], v[20:21]
    v_pk_mul_f32 v[192:193], v[192:193], v[22:23]
    v_cvt_pk_bf16_f32 v200, v168, v169
    v_cvt_pk_bf16_f32 v201, v176, v177
    v_cvt_pk_bf16_f32 v202, v184, v185
    v_cvt_pk_bf16_f32 v203, v192, v193
    buffer_store_dwordx4 v[200:203], v240, s[16:19], s60 offen offset:0 sc1
    ds_read_b32 v14, v15 offset:80
    v_pk_fma_f32 v[24:25], v[216:217], v[128:129], v[24:25] neg_lo:[0,1,0] neg_hi:[0,1,0]
    v_pk_fma_f32 v[26:27], v[218:219], v[128:129], v[26:27] neg_lo:[0,1,0] neg_hi:[0,1,0]
    v_pk_fma_f32 v[28:29], v[216:217], v[136:137], v[28:29] neg_lo:[0,1,0] neg_hi:[0,1,0]
    v_pk_fma_f32 v[30:31], v[218:219], v[136:137], v[30:31] neg_lo:[0,1,0] neg_hi:[0,1,0]
    v_pk_mul_f32 v[168:169], v[24:25], v[24:25]
    v_pk_mul_f32 v[176:177], v[26:27], v[26:27]
    v_pk_mul_f32 v[184:185], v[28:29], v[28:29]
    v_pk_mul_f32 v[192:193], v[30:31], v[30:31]
    v_pk_fma_f32 v[168:169], v[168:169], v[132:133], v[130:131]
    v_pk_fma_f32 v[176:177], v[176:177], v[132:133], v[130:131]
    v_pk_fma_f32 v[184:185], v[184:185], v[140:141], v[138:139]
    v_pk_fma_f32 v[192:193], v[192:193], v[140:141], v[138:139]
    v_pk_mul_f32 v[168:169], v[168:169], v[24:25]
    v_pk_mul_f32 v[176:177], v[176:177], v[26:27]
    v_pk_mul_f32 v[184:185], v[184:185], v[28:29]
    v_pk_mul_f32 v[192:193], v[192:193], v[30:31]
    v_exp_f32 v168, v168
    v_exp_f32 v169, v169
    v_exp_f32 v176, v176
    v_exp_f32 v177, v177
    v_exp_f32 v184, v184
    v_exp_f32 v185, v185
    v_exp_f32 v192, v192
    v_exp_f32 v193, v193
    v_pk_fma_f32 v[40:41], v[220:221], v[128:129], v[40:41] neg_lo:[0,1,0] neg_hi:[0,1,0]
    v_pk_fma_f32 v[42:43], v[222:223], v[128:129], v[42:43] neg_lo:[0,1,0] neg_hi:[0,1,0]
    v_pk_fma_f32 v[44:45], v[220:221], v[136:137], v[44:45] neg_lo:[0,1,0] neg_hi:[0,1,0]
    v_pk_fma_f32 v[46:47], v[222:223], v[136:137], v[46:47] neg_lo:[0,1,0] neg_hi:[0,1,0]
    v_pk_fma_f32 v[168:169], v[168:169], v[134:135], v[134:135]
    v_pk_fma_f32 v[176:177], v[176:177], v[134:135], v[134:135]
    v_pk_fma_f32 v[184:185], v[184:185], v[142:143], v[142:143]
    v_pk_fma_f32 v[192:193], v[192:193], v[142:143], v[142:143]
    v_rcp_f32 v168, v168
    v_rcp_f32 v169, v169
    v_rcp_f32 v176, v176
    v_rcp_f32 v177, v177
    v_rcp_f32 v184, v184
    v_rcp_f32 v185, v185
    v_rcp_f32 v192, v192
    v_rcp_f32 v193, v193
    v_pk_mul_f32 v[24:25], v[24:25], v[40:41]
    v_pk_mul_f32 v[26:27], v[26:27], v[42:43]
    v_pk_mul_f32 v[28:29], v[28:29], v[44:45]
    v_pk_mul_f32 v[30:31], v[30:31], v[46:47]
    v_pk_mul_f32 v[168:169], v[168:169], v[24:25]
    v_pk_mul_f32 v[176:177], v[176:177], v[26:27]
    v_pk_mul_f32 v[184:185], v[184:185], v[28:29]
    v_pk_mul_f32 v[192:193], v[192:193], v[30:31]
    v_cvt_pk_bf16_f32 v204, v168, v169
    v_cvt_pk_bf16_f32 v205, v176, v177
    v_cvt_pk_bf16_f32 v206, v184, v185
    v_cvt_pk_bf16_f32 v207, v192, v193
    buffer_store_dwordx4 v[204:207], v240, s[16:19], s61 offen offset:0 sc1
    s_waitcnt lgkmcnt(0)
    v_readfirstlane_b32 s53, v14
    s_nop 0
    s_cmp_ge_u32 s53, 1
    s_cbranch_scc1 wd_ok_11
lw_12:
    ds_read_b32 v14, v15 offset:80
    s_waitcnt lgkmcnt(0)
    s_nop 0
    v_readfirstlane_b32 s53, v14
    s_nop 0
    s_cmp_ge_u32 s53, 1
    s_cbranch_scc1 lw_ok_13
    s_add_u32 s75, s75, 1
    s_cmp_lt_u32 s75, 4194304
    s_cbranch_scc1 lw_12
lw_ok_13:
wd_ok_11:
    ds_read_b64_tr_b16 v[16:17], v246 offset:0
    v_pk_fma_f32 v[48:49], v[224:225], v[112:113], v[48:49] neg_lo:[0,1,0] neg_hi:[0,1,0]
    v_pk_fma_f32 v[50:51], v[226:227], v[112:113], v[50:51] neg_lo:[0,1,0] neg_hi:[0,1,0]
    ds_read_b64_tr_b16 v[18:19], v246 offset:2048
    v_pk_fma_f32 v[52:53], v[224:225], v[120:121], v[52:53] neg_lo:[0,1,0] neg_hi:[0,1,0]
    v_pk_fma_f32 v[54:55], v[226:227], v[120:121], v[54:55] neg_lo:[0,1,0] neg_hi:[0,1,0]
    ds_read_b64_tr_b16 v[20:21], v247 offset:0
    v_pk_mul_f32 v[168:169], v[48:49], v[48:49]
    v_pk_mul_f32 v[176:177], v[50:51], v[50:51]
    ds_read_b64_tr_b16 v[22:23], v247 offset:2048
    v_pk_mul_f32 v[184:185], v[52:53], v[52:53]
    v_pk_mul_f32 v[192:193], v[54:55], v[54:55]
    ds_read_b64_tr_b16 v[24:25], v248 offset:0
    v_pk_fma_f32 v[168:169], v[168:169], v[116:117], v[114:115]
    v_pk_fma_f32 v[176:177], v[176:177], v[116:117], v[114:115]
    ds_read_b64_tr_b16 v[26:27], v248 offset:2048
    v_pk_fma_f32 v[184:185], v[184:185], v[124:125], v[122:123]
    v_pk_fma_f32 v[192:193], v[192:193], v[124:125], v[122:123]
    ds_read_b64_tr_b16 v[28:29], v249 offset:0
    v_pk_mul_f32 v[168:169], v[168:169], v[48:49]
    v_pk_mul_f32 v[176:177], v[176:177], v[50:51]
    ds_read_b64_tr_b16 v[30:31], v249 offset:2048
    v_pk_mul_f32 v[184:185], v[184:185], v[52:53]
    v_pk_mul_f32 v[192:193], v[192:193], v[54:55]
    ds_read_b64_tr_b16 v[32:33], v246 offset:4096
    v_exp_f32 v168, v168
    v_exp_f32 v169, v169
    v_exp_f32 v176, v176
    v_exp_f32 v177, v177
    ds_read_b64_tr_b16 v[34:35], v246 offset:6144
    v_exp_f32 v184, v184
    v_exp_f32 v185, v185
    v_exp_f32 v192, v192
    v_exp_f32 v193, v193
    ds_read_b64_tr_b16 v[36:37], v247 offset:4096
    v_pk_fma_f32 v[64:65], v[228:229], v[112:113], v[64:65] neg_lo:[0,1,0] neg_hi:[0,1,0]
    v_pk_fma_f32 v[66:67], v[230:231], v[112:113], v[66:67] neg_lo:[0,1,0] neg_hi:[0,1,0]
    ds_read_b64_tr_b16 v[38:39], v247 offset:6144
    v_pk_fma_f32 v[68:69], v[228:229], v[120:121], v[68:69] neg_lo:[0,1,0] neg_hi:[0,1,0]
    v_pk_fma_f32 v[70:71], v[230:231], v[120:121], v[70:71] neg_lo:[0,1,0] neg_hi:[0,1,0]
    ds_read_b64_tr_b16 v[40:41], v248 offset:4096
    v_pk_fma_f32 v[168:169], v[168:169], v[118:119], v[118:119]
    v_pk_fma_f32 v[176:177], v[176:177], v[118:119], v[118:119]
    ds_read_b64_tr_b16 v[42:43], v248 offset:6144
    v_pk_fma_f32 v[184:185], v[184:185], v[126:127], v[126:127]
    v_pk_fma_f32 v[192:193], v[192:193], v[126:127], v[126:127]
    ds_read_b64_tr_b16 v[44:45], v249 offset:4096
    v_rcp_f32 v168, v168
    v_rcp_f32 v169, v169
    v_rcp_f32 v176, v176
    v_rcp_f32 v177, v177
    ds_read_b64_tr_b16 v[46:47], v249 offset:6144
    v_rcp_f32 v184, v184
    v_rcp_f32 v185, v185
    v_rcp_f32 v192, v192
    v_rcp_f32 v193, v193
    v_pk_mul_f32 v[48:49], v[48:49], v[64:65]
    v_pk_mul_f32 v[50:51], v[50:51], v[66:67]
    v_pk_mul_f32 v[52:53], v[52:53], v[68:69]
    v_pk_mul_f32 v[54:55], v[54:55], v[70:71]
    v_pk_mul_f32 v[168:169], v[168:169], v[48:49]
    v_pk_mul_f32 v[176:177], v[176:177], v[50:51]
    v_pk_mul_f32 v[184:185], v[184:185], v[52:53]
    v_pk_mul_f32 v[192:193], v[192:193], v[54:55]
    v_cvt_pk_bf16_f32 v200, v168, v169
    v_cvt_pk_bf16_f32 v201, v176, v177
    v_cvt_pk_bf16_f32 v202, v184, v185
    v_cvt_pk_bf16_f32 v203, v192, v193
    buffer_store_dwordx4 v[200:203], v240, s[16:19], s60 offen offset:1024 sc1
    ds_read_b32 v14, v15 offset:80
    v_pk_fma_f32 v[56:57], v[224:225], v[128:129], v[56:57] neg_lo:[0,1,0] neg_hi:[0,1,0]
    v_pk_fma_f32 v[58:59], v[226:227], v[128:129], v[58:59] neg_lo:[0,1,0] neg_hi:[0,1,0]
    v_pk_fma_f32 v[60:61], v[224:225], v[136:137], v[60:61] neg_lo:[0,1,0] neg_hi:[0,1,0]
    v_pk_fma_f32 v[62:63], v[226:227], v[136:137], v[62:63] neg_lo:[0,1,0] neg_hi:[0,1,0]
    v_pk_mul_f32 v[168:169], v[56:57], v[56:57]
    v_pk_mul_f32 v[176:177], v[58:59], v[58:59]
    v_pk_mul_f32 v[184:185], v[60:61], v[60:61]
    v_pk_mul_f32 v[192:193], v[62:63], v[62:63]
    v_pk_fma_f32 v[168:169], v[168:169], v[132:133], v[130:131]
    v_pk_fma_f32 v[176:177], v[176:177], v[132:133], v[130:131]
    v_pk_fma_f32 v[184:185], v[184:185], v[140:141], v[138:139]
    v_pk_fma_f32 v[192:193], v[192:193], v[140:141], v[138:139]
    v_pk_mul_f32 v[168:169], v[168:169], v[56:57]
    v_pk_mul_f32 v[176:177], v[176:177], v[58:59]
    v_pk_mul_f32 v[184:185], v[184:185], v[60:61]
    v_pk_mul_f32 v[192:193], v[192:193], v[62:63]
    v_exp_f32 v168, v168
    v_exp_f32 v169, v169
    v_exp_f32 v176, v176
    v_exp_f32 v177, v177
    v_exp_f32 v184, v184
    v_exp_f32 v185, v185
    v_exp_f32 v192, v192
    v_exp_f32 v193, v193
    v_pk_fma_f32 v[72:73], v[228:229], v[128:129], v[72:73] neg_lo:[0,1,0] neg_hi:[0,1,0]
    v_pk_fma_f32 v[74:75], v[230:231], v[128:129], v[74:75] neg_lo:[0,1,0] neg_hi:[0,1,0]
    v_pk_fma_f32 v[76:77], v[228:229], v[136:137], v[76:77] neg_lo:[0,1,0] neg_hi:[0,1,0]
    v_pk_fma_f32 v[78:79], v[230:231], v[136:137], v[78:79] neg_lo:[0,1,0] neg_hi:[0,1,0]
    v_pk_fma_f32 v[168:169], v[168:169], v[134:135], v[134:135]
    v_pk_fma_f32 v[176:177], v[176:177], v[134:135], v[134:135]
    v_pk_fma_f32 v[184:185], v[184:185], v[142:143], v[142:143]
    v_pk_fma_f32 v[192:193], v[192:193], v[142:143], v[142:143]
    v_rcp_f32 v168, v168
    v_rcp_f32 v169, v169
    v_rcp_f32 v176, v176
    v_rcp_f32 v177, v177
    v_rcp_f32 v184, v184
    v_rcp_f32 v185, v185
    v_rcp_f32 v192, v192
    v_rcp_f32 v193, v193
    v_pk_mul_f32 v[56:57], v[56:57], v[72:73]
    v_pk_mul_f32 v[58:59], v[58:59], v[74:75]
    v_pk_mul_f32 v[60:61], v[60:61], v[76:77]
    v_pk_mul_f32 v[62:63], v[62:63], v[78:79]
    v_pk_mul_f32 v[168:169], v[168:169], v[56:57]
    v_pk_mul_f32 v[176:177], v[176:177], v[58:59]
    v_pk_mul_f32 v[184:185], v[184:185], v[60:61]
    v_pk_mul_f32 v[192:193], v[192:193], v[62:63]
    v_cvt_pk_bf16_f32 v204, v168, v169
    v_cvt_pk_bf16_f32 v205, v176, v177
    v_cvt_pk_bf16_f32 v206, v184, v185
    v_cvt_pk_bf16_f32 v207, v192, v193
    buffer_store_dwordx4 v[204:207], v240, s[16:19], s61 offen offset:1024 sc1
    s_cbranch_vccnz ep_two_9
    v_pk_fma_f32 v[80:81], v[232:233], v[112:113], v[80:81] neg_lo:[0,1,0] neg_hi:[0,1,0]
    v_pk_fma_f32 v[82:83], v[234:235], v[112:113], v[82:83] neg_lo:[0,1,0] neg_hi:[0,1,0]
    v_pk_fma_f32 v[84:85], v[232:233], v[120:121], v[84:85] neg_lo:[0,1,0] neg_hi:[0,1,0]
    v_pk_fma_f32 v[86:87], v[234:235], v[120:121], v[86:87] neg_lo:[0,1,0] neg_hi:[0,1,0]
    v_pk_mul_f32 v[168:169], v[80:81], v[80:81]
    v_pk_mul_f32 v[176:177], v[82:83], v[82:83]
    v_pk_mul_f32 v[184:185], v[84:85], v[84:85]
    v_pk_mul_f32 v[192:193], v[86:87], v[86:87]
    v_pk_fma_f32 v[168:169], v[168:169], v[116:117], v[114:115]
    v_pk_fma_f32 v[176:177], v[176:177], v[116:117], v[114:115]
    v_pk_fma_f32 v[184:185], v[184:185], v[124:125], v[122:123]
    v_pk_fma_f32 v[192:193], v[192:193], v[124:125], v[122:123]
    v_pk_mul_f32 v[168:169], v[168:169], v[80:81]
    v_pk_mul_f32 v[176:177], v[176:177], v[82:83]
    v_pk_mul_f32 v[184:185], v[184:185], v[84:85]
    v_pk_mul_f32 v[192:193], v[192:193], v[86:87]
    v_exp_f32 v168, v168
    v_exp_f32 v169, v169
    v_exp_f32 v176, v176
    v_exp_f32 v177, v177
    v_exp_f32 v184, v184
    v_exp_f32 v185, v185
    v_exp_f32 v192, v192
    v_exp_f32 v193, v193
    v_pk_fma_f32 v[96:97], v[236:237], v[112:113], v[96:97] neg_lo:[0,1,0] neg_hi:[0,1,0]
    v_pk_fma_f32 v[98:99], v[238:239], v[112:113], v[98:99] neg_lo:[0,1,0] neg_hi:[0,1,0]
    v_pk_fma_f32 v[100:101], v[236:237], v[120:121], v[100:101] neg_lo:[0,1,0] neg_hi:[0,1,0]
    v_pk_fma_f32 v[102:103], v[238:239], v[120:121], v[102:103] neg_lo:[0,1,0] neg_hi:[0,1,0]
    v_pk_fma_f32 v[168:169], v[168:169], v[118:119], v[118:119]
    v_pk_fma_f32 v[176:177], v[176:177], v[118:119], v[118:119]
    v_pk_fma_f32 v[184:185], v[184:185], v[126:127], v[126:127]
    v_pk_fma_f32 v[192:193], v[192:193], v[126:127], v[126:127]
    v_rcp_f32 v168, v168
    v_rcp_f32 v169, v169
    v_rcp_f32 v176, v176
    v_rcp_f32 v177, v177
    v_rcp_f32 v184, v184
    v_rcp_f32 v185, v185
    v_rcp_f32 v192, v192
    v_rcp_f32 v193, v193
    v_pk_mul_f32 v[80:81], v[80:81], v[96:97]
    v_pk_mul_f32 v[82:83], v[82:83], v[98:99]
    v_pk_mul_f32 v[84:85], v[84:85], v[100:101]
    v_pk_mul_f32 v[86:87], v[86:87], v[102:103]
    v_pk_mul_f32 v[168:169], v[168:169], v[80:81]
    v_pk_mul_f32 v[176:177], v[176:177], v[82:83]
    v_pk_mul_f32 v[184:185], v[184:185], v[84:85]
    v_pk_mul_f32 v[192:193], v[192:193], v[86:87]
    v_cvt_pk_bf16_f32 v200, v168, v169
    v_cvt_pk_bf16_f32 v201, v176, v177
    v_cvt_pk_bf16_f32 v202, v184, v185
    v_cvt_pk_bf16_f32 v203, v192, v193
    buffer_store_dwordx4 v[200:203], v240, s[16:19], s60 offen offset:2048 sc1
    ds_read_b32 v14, v15 offset:80
    v_pk_fma_f32 v[88:89], v[232:233], v[128:129], v[88:89] neg_lo:[0,1,0] neg_hi:[0,1,0]
    v_pk_fma_f32 v[90:91], v[234:235], v[128:129], v[90:91] neg_lo:[0,1,0] neg_hi:[0,1,0]
    v_pk_fma_f32 v[92:93], v[232:233], v[136:137], v[92:93] neg_lo:[0,1,0] neg_hi:[0,1,0]
    v_pk_fma_f32 v[94:95], v[234:235], v[136:137], v[94:95] neg_lo:[0,1,0] neg_hi:[0,1,0]
    v_pk_mul_f32 v[168:169], v[88:89], v[88:89]
    v_pk_mul_f32 v[176:177], v[90:91], v[90:91]
    v_pk_mul_f32 v[184:185], v[92:93], v[92:93]
    v_pk_mul_f32 v[192:193], v[94:95], v[94:95]
    v_pk_fma_f32 v[168:169], v[168:169], v[132:133], v[130:131]
    v_pk_fma_f32 v[176:177], v[176:177], v[132:133], v[130:131]
    v_pk_fma_f32 v[184:185], v[184:185], v[140:141], v[138:139]
    v_pk_fma_f32 v[192:193], v[192:193], v[140:141], v[138:139]
    v_pk_mul_f32 v[168:169], v[168:169], v[88:89]
    v_pk_mul_f32 v[176:177], v[176:177], v[90:91]
    v_pk_mul_f32 v[184:185], v[184:185], v[92:93]
    v_pk_mul_f32 v[192:193], v[192:193], v[94:95]
    v_exp_f32 v168, v168
    v_exp_f32 v169, v169
    v_exp_f32 v176, v176
    v_exp_f32 v177, v177
    v_exp_f32 v184, v184
    v_exp_f32 v185, v185
    v_exp_f32 v192, v192
    v_exp_f32 v193, v193
    v_pk_fma_f32 v[104:105], v[236:237], v[128:129], v[104:105] neg_lo:[0,1,0] neg_hi:[0,1,0]
    v_pk_fma_f32 v[106:107], v[238:239], v[128:129], v[106:107] neg_lo:[0,1,0] neg_hi:[0,1,0]
    v_pk_fma_f32 v[108:109], v[236:237], v[136:137], v[108:109] neg_lo:[0,1,0] neg_hi:[0,1,0]
    v_pk_fma_f32 v[110:111], v[238:239], v[136:137], v[110:111] neg_lo:[0,1,0] neg_hi:[0,1,0]
    v_pk_fma_f32 v[168:169], v[168:169], v[134:135], v[134:135]
    v_pk_fma_f32 v[176:177], v[176:177], v[134:135], v[134:135]
    v_pk_fma_f32 v[184:185], v[184:185], v[142:143], v[142:143]
    v_pk_fma_f32 v[192:193], v[192:193], v[142:143], v[142:143]
    v_rcp_f32 v168, v168
    v_rcp_f32 v169, v169
    v_rcp_f32 v176, v176
    v_rcp_f32 v177, v177
    v_rcp_f32 v184, v184
    v_rcp_f32 v185, v185
    v_rcp_f32 v192, v192
    v_rcp_f32 v193, v193
    v_pk_mul_f32 v[88:89], v[88:89], v[104:105]
    v_pk_mul_f32 v[90:91], v[90:91], v[106:107]
    v_pk_mul_f32 v[92:93], v[92:93], v[108:109]
    v_pk_mul_f32 v[94:95], v[94:95], v[110:111]
    v_pk_mul_f32 v[168:169], v[168:169], v[88:89]
    v_pk_mul_f32 v[176:177], v[176:177], v[90:91]
    v_pk_mul_f32 v[184:185], v[184:185], v[92:93]
    v_pk_mul_f32 v[192:193], v[192:193], v[94:95]
    v_cvt_pk_bf16_f32 v204, v168, v169
    v_cvt_pk_bf16_f32 v205, v176, v177
    v_cvt_pk_bf16_f32 v206, v184, v185
    v_cvt_pk_bf16_f32 v207, v192, v193
    buffer_store_dwordx4 v[204:207], v240, s[16:19], s61 offen offset:2048 sc1
ep_two_9:
    s_mov_b64 exec, 1
    ds_add_u32 v12, v13
    s_mov_b64 exec, -1
    s_lshl_b32 s53, s49, 1
    s_add_u32 s53, s53, s65
    s_lshl_b32 s53, s53, 4
    s_add_u32 s53, s53, s50
    s_lshl_b32 s53, s53, 1
    s_add_u32 s53, s53, s66
    s_lshl_b32 s53, s53, 7
    s_add_u32 s55, s53, 0xaa0000
    s_waitcnt lgkmcnt(0)
    s_lshl_b32 s56, s3, 15
    s_add_u32 s56, s56, s74
    s_add_u32 m0, s101, 0
    s_nop 0
    buffer_load_dwordx4 v241, s[32:35], s56 offen  lds
    s_add_u32 m0, s101, 1024
    s_add_u32 s56, s56, 8192
    buffer_load_dwordx4 v241, s[32:35], s56 offen  lds
    s_add_u32 m0, s101, 2048
    s_add_u32 s56, s56, 8192
    buffer_load_dwordx4 v241, s[32:35], s56 offen  lds
    s_add_u32 m0, s101, 3072
    s_add_u32 s56, s56, 8192
    buffer_load_dwordx4 v241, s[32:35], s56 offen  lds
    s_add_u32 s3, s3, 1
    s_cmp_eq_u32 s3, 11
    s_cselect_b32 s3, 0, s3
    s_lshl_b32 s56, s3, 15
    s_add_u32 s56, s56, s74
    s_add_u32 m0, s101, 4096
    s_nop 0
    buffer_load_dwordx4 v241, s[32:35], s56 offen  lds
    s_add_u32 m0, s101, 5120
    s_add_u32 s56, s56, 8192
    buffer_load_dwordx4 v241, s[32:35], s56 offen  lds
    s_add_u32 m0, s101, 6144
    s_add_u32 s56, s56, 8192
    buffer_load_dwordx4 v241, s[32:35], s56 offen  lds
    s_add_u32 m0, s101, 7168
    s_add_u32 s56, s56, 8192
    buffer_load_dwordx4 v241, s[32:35], s56 offen  lds
    s_add_u32 s3, s3, 1
    s_cmp_eq_u32 s3, 11
    s_cselect_b32 s3, 0, s3
    s_waitcnt vmcnt(8)
    v_mov_b32 v10, s70
    v_mov_b32 v11, 0
    s_mov_b64 exec, 1
    buffer_store_dword v10, v11, s[16:19], s55 offen sc1
    s_mov_b64 exec, -1
    s_waitcnt lgkmcnt(0)
    v_readfirstlane_b32 s53, v14
    s_nop 0
    s_cmp_ge_u32 s53, 2
    s_cbranch_scc1 wd_ok_14
lw_15:
    ds_read_b32 v14, v15 offset:80
    s_waitcnt lgkmcnt(0)
    s_nop 0
    v_readfirstlane_b32 s53, v14
    s_nop 0
    s_cmp_ge_u32 s53, 2
    s_cbranch_scc1 lw_ok_16
    s_add_u32 s75, s75, 1
    s_cmp_lt_u32 s75, 4194304
    s_cbranch_scc1 lw_15
lw_ok_16:
wd_ok_14:
    ds_read_b64_tr_b16 v[48:49], v242 offset:0
    ds_read_b64_tr_b16 v[50:51], v242 offset:2048
    ds_read_b64_tr_b16 v[52:53], v243 offset:0
    ds_read_b64_tr_b16 v[54:55], v243 offset:2048
    ds_read_b64_tr_b16 v[56:57], v244 offset:0
    ds_read_b64_tr_b16 v[58:59], v244 offset:2048
    ds_read_b64_tr_b16 v[60:61], v245 offset:0
    ds_read_b64_tr_b16 v[62:63], v245 offset:2048
    ds_read_b64_tr_b16 v[64:65], v242 offset:16384
    ds_read_b64_tr_b16 v[66:67], v242 offset:18432
    ds_read_b64_tr_b16 v[68:69], v243 offset:16384
    ds_read_b64_tr_b16 v[70:71], v243 offset:18432
    ds_read_b64_tr_b16 v[72:73], v244 offset:16384
    ds_read_b64_tr_b16 v[74:75], v244 offset:18432
    ds_read_b64_tr_b16 v[76:77], v245 offset:16384
    ds_read_b64_tr_b16 v[78:79], v245 offset:18432
    s_waitcnt lgkmcnt(0)
    s_lshl_b32 s56, s3, 15
    s_add_u32 s56, s56, s74
    s_add_u32 m0, s59, 0
    s_nop 0
    buffer_load_dwordx4 v241, s[32:35], s56 offen  lds
    s_add_u32 m0, s59, 1024
    s_add_u32 s56, s56, 8192
    buffer_load_dwordx4 v241, s[32:35], s56 offen  lds
    s_add_u32 m0, s59, 2048
    s_add_u32 s56, s56, 8192
    buffer_load_dwordx4 v241, s[32:35], s56 offen  lds
    s_add_u32 m0, s59, 3072
    s_add_u32 s56, s56, 8192
    buffer_load_dwordx4 v241, s[32:35], s56 offen  lds
    s_add_u32 s3, s3, 1
    s_cmp_eq_u32 s3, 11
    s_cselect_b32 s3, 0, s3
    s_lshl_b32 s56, s3, 15
    s_add_u32 s56, s56, s74
    s_add_u32 m0, s59, 16384
    s_nop 0
    buffer_load_dwordx4 v241, s[32:35], s56 offen  lds
    s_add_u32 m0, s59, 17408
    s_add_u32 s56, s56, 8192
    buffer_load_dwordx4 v241, s[32:35], s56 offen  lds
    s_add_u32 m0, s59, 18432
    s_add_u32 s56, s56, 8192
    buffer_load_dwordx4 v241, s[32:35], s56 offen  lds
    s_add_u32 m0, s59, 19456
    s_add_u32 s56, s56, 8192
    buffer_load_dwordx4 v241, s[32:35], s56 offen  lds
    s_add_u32 s3, s3, 1
    s_cmp_eq_u32 s3, 11
    s_cselect_b32 s3, 0, s3
    s_lshl_b32 s53, s2, 3
    s_add_u32 s53, s53, s48
    s_cmp_lg_u32 s53, 0
    s_cbranch_scc1 ep_skip_17
    v_lshlrev_b32 v6, 7, v0
    s_mov_b32 s53, 0xa80000
    buffer_load_dword v2, v6, s[16:19], s53 offen sc1
    s_add_u32 s53, s53, 8192
    buffer_load_dword v3, v6, s[16:19], s53 offen sc1
    s_add_u32 s53, s53, 8192
    buffer_load_dword v4, v6, s[16:19], s53 offen sc1
    s_add_u32 s53, s53, 8192
    buffer_load_dword v5, v6, s[16:19], s53 offen sc1
    s_add_u32 s53, s53, 8192
ep_skip_17:
    s_setprio 2
    s_mov_b32 s57, 0
    s_mov_b32 s75, 0
    s_cmp_ge_u32 s57, 1
    s_cbranch_scc1 g2ok_1
g2p_1:
    buffer_load_dword v10, v254, s[16:19], 0 offen sc1
    s_add_u32 s75, s75, 1
    s_waitcnt vmcnt(0)
    v_cmp_ne_u32 vcc, s70, v10
    s_cmp_ge_u32 s75, 65536
    s_cbranch_scc1 g2ok_1
    s_lshr_b32 s53, vcc_lo, 16
    s_or_b32 s53, s53, vcc_lo
    s_bitset1_b32 s53, 11
    s_ff1_i32_b32 s57, s53
    s_cmp_ge_u32 s57, 1
    s_cbranch_scc1 g2ok_1
    s_sleep 2
    s_branch g2p_1
g2ok_1:
    s_lshl_b32 s54, s71, 11
    s_add_u32 s54, s54, s73
    s_cmp_eq_u32 s71, s72
    s_cselect_b32 s54, 0x7f000000, s54
    buffer_load_dwordx4 v[80:83], v240, s[16:19], s54 offen offset:0 sc1
    buffer_load_dwordx4 v[84:87], v240, s[16:19], s54 offen offset:1024 sc1
    s_add_u32 s54, s54, 88064
    buffer_load_dwordx4 v[88:91], v240, s[16:19], s54 offen offset:0 sc1
    buffer_load_dwordx4 v[92:95], v240, s[16:19], s54 offen offset:1024 sc1
    s_add_u32 s71, s71, 1
    s_cmp_eq_u32 s71, 11
    s_cselect_b32 s71, 0, s71
    s_cmp_ge_u32 s57, 2
    s_cbranch_scc1 g2ok_2
g2p_2:
    buffer_load_dword v10, v254, s[16:19], 0 offen sc1
    s_add_u32 s75, s75, 1
    s_waitcnt vmcnt(0)
    v_cmp_ne_u32 vcc, s70, v10
    s_cmp_ge_u32 s75, 65536
    s_cbranch_scc1 g2ok_2
    s_lshr_b32 s53, vcc_lo, 16
    s_or_b32 s53, s53, vcc_lo
    s_bitset1_b32 s53, 11
    s_ff1_i32_b32 s57, s53
    s_cmp_ge_u32 s57, 2
    s_cbranch_scc1 g2ok_2
    s_sleep 2
    s_branch g2p_2
g2ok_2:
    s_lshl_b32 s54, s71, 11
    s_add_u32 s54, s54, s73
    s_cmp_eq_u32 s71, s72
    s_cselect_b32 s54, 0x7f000000, s54
    buffer_load_dwordx4 v[96:99], v240, s[16:19], s54 offen offset:0 sc1
    buffer_load_dwordx4 v[100:103], v240, s[16:19], s54 offen offset:1024 sc1
    s_add_u32 s54, s54, 88064
    buffer_load_dwordx4 v[104:107], v240, s[16:19], s54 offen offset:0 sc1
    buffer_load_dwordx4 v[108:111], v240, s[16:19], s54 offen offset:1024 sc1
    s_add_u32 s71, s71, 1
    s_cmp_eq_u32 s71, 11
    s_cselect_b32 s71, 0, s71
    s_cmp_ge_u32 s57, 3
    s_cbranch_scc1 g2ok_3
g2p_3:
    buffer_load_dword v10, v254, s[16:19], 0 offen sc1
    s_add_u32 s75, s75, 1
    s_waitcnt vmcnt(0)
    v_cmp_ne_u32 vcc, s70, v10
    s_cmp_ge_u32 s75, 65536
    s_cbranch_scc1 g2ok_3
    s_lshr_b32 s53, vcc_lo, 16
    s_or_b32 s53, s53, vcc_lo
    s_bitset1_b32 s53, 11
    s_ff1_i32_b32 s57, s53
    s_cmp_ge_u32 s57, 3
    s_cbranch_scc1 g2ok_3
    s_sleep 2
    s_branch g2p_3
g2ok_3:
    s_lshl_b32 s54, s71, 11
    s_add_u32 s54, s54, s73
    s_cmp_eq_u32 s71, s72
    s_cselect_b32 s54, 0x7f000000, s54
    buffer_load_dwordx4 v[112:115], v240, s[16:19], s54 offen offset:0 sc1
    buffer_load_dwordx4 v[116:119], v240, s[16:19], s54 offen offset:1024 sc1
    s_add_u32 s54, s54, 88064
    buffer_load_dwordx4 v[120:123], v240, s[16:19], s54 offen offset:0 sc1
    buffer_load_dwordx4 v[124:127], v240, s[16:19], s54 offen offset:1024 sc1
    s_add_u32 s71, s71, 1
    s_cmp_eq_u32 s71, 11
    s_cselect_b32 s71, 0, s71
    s_cmp_ge_u32 s57, 4
    s_cbranch_scc1 g2ok_4
g2p_4:
    buffer_load_dword v10, v254, s[16:19], 0 offen sc1
    s_add_u32 s75, s75, 1
    s_waitcnt vmcnt(0)
    v_cmp_ne_u32 vcc, s70, v10
    s_cmp_ge_u32 s75, 65536
    s_cbranch_scc1 g2ok_4
    s_lshr_b32 s53, vcc_lo, 16
    s_or_b32 s53, s53, vcc_lo
    s_bitset1_b32 s53, 11
    s_ff1_i32_b32 s57, s53
    s_cmp_ge_u32 s57, 4
    s_cbranch_scc1 g2ok_4
    s_sleep 2
    s_branch g2p_4
g2ok_4:
    s_lshl_b32 s54, s71, 11
    s_add_u32 s54, s54, s73
    s_cmp_eq_u32 s71, s72
    s_cselect_b32 s54, 0x7f000000, s54
    buffer_load_dwordx4 v[128:131], v240, s[16:19], s54 offen offset:0 sc1
    buffer_load_dwordx4 v[132:135], v240, s[16:19], s54 offen offset:1024 sc1
    s_add_u32 s54, s54, 88064
    buffer_load_dwordx4 v[136:139], v240, s[16:19], s54 offen offset:0 sc1
    buffer_load_dwordx4 v[140:143], v240, s[16:19], s54 offen offset:1024 sc1
    s_add_u32 s71, s71, 1
    s_cmp_eq_u32 s71, 11
    s_cselect_b32 s71, 0, s71
    s_cmp_ge_u32 s57, 5
    s_cbranch_scc1 g2ok_5
g2p_5:
    buffer_load_dword v10, v254, s[16:19], 0 offen sc1
    s_add_u32 s75, s75, 1
    s_waitcnt vmcnt(0)
    v_cmp_ne_u32 vcc, s70, v10
    s_cmp_ge_u32 s75, 65536
    s_cbranch_scc1 g2ok_5
    s_lshr_b32 s53, vcc_lo, 16
    s_or_b32 s53, s53, vcc_lo
    s_bitset1_b32 s53, 11
    s_ff1_i32_b32 s57, s53
    s_cmp_ge_u32 s57, 5
    s_cbranch_scc1 g2ok_5
    s_sleep 2
    s_branch g2p_5
g2ok_5:
    s_lshl_b32 s54, s71, 11
    s_add_u32 s54, s54, s73
    s_cmp_eq_u32 s71, s72
    s_cselect_b32 s54, 0x7f000000, s54
    buffer_load_dwordx4 v[144:147], v240, s[16:19], s54 offen offset:0 sc1
    buffer_load_dwordx4 v[148:151], v240, s[16:19], s54 offen offset:1024 sc1
    s_add_u32 s54, s54, 88064
    buffer_load_dwordx4 v[152:155], v240, s[16:19], s54 offen offset:0 sc1
    buffer_load_dwordx4 v[156:159], v240, s[16:19], s54 offen offset:1024 sc1
    s_add_u32 s71, s71, 1
    s_cmp_eq_u32 s71, 11
    s_cselect_b32 s71, 0, s71
lw_18:
    ds_read_b32 v14, v15 offset:80
    s_waitcnt lgkmcnt(0)
    s_nop 0
    v_readfirstlane_b32 s53, v14
    s_nop 0
    s_cmp_ge_u32 s53, 3
    s_cbranch_scc1 lw_ok_19
    s_add_u32 s75, s75, 1
    s_cmp_lt_u32 s75, 4194304
    s_cbranch_scc1 lw_18
lw_ok_19:
    s_waitcnt vmcnt(18)
    v_swap_b32 v82, v84
    v_swap_b32 v83, v85
    s_nop 1
    v_mfma_f32_16x16x32_bf16 v[176:179], v[16:19], v[80:83], 0
    s_cmp_ge_u32 s57, 6
    s_cbranch_scc1 g2ok_6
g2p_6:
    buffer_load_dword v10, v254, s[16:19], 0 offen sc1
    s_add_u32 s75, s75, 1
    s_waitcnt vmcnt(0)
    v_cmp_ne_u32 vcc, s70, v10
    s_cmp_ge_u32 s75, 65536
    s_cbranch_scc1 g2ok_6
    s_lshr_b32 s53, vcc_lo, 16
    s_or_b32 s53, s53, vcc_lo
    s_bitset1_b32 s53, 11
    s_ff1_i32_b32 s57, s53
    s_cmp_ge_u32 s57, 6
    s_cbranch_scc1 g2ok_6
    s_sleep 2
    s_branch g2p_6
g2ok_6:
    s_lshl_b32 s54, s71, 11
    s_add_u32 s54, s54, s73
    s_cmp_eq_u32 s71, s72
    s_cselect_b32 s54, 0x7f000000, s54
    buffer_load_dwordx4 v[160:163], v240, s[16:19], s54 offen offset:0 sc1
    v_mfma_f32_16x16x32_bf16 v[180:183], v[16:19], v[84:87], 0
    v_mfma_f32_16x16x32_bf16 v[192:195], v[20:23], v[80:83], 0
    v_mfma_f32_16x16x32_bf16 v[196:199], v[20:23], v[84:87], 0
    s_waitcnt vmcnt(17)
    v_swap_b32 v90, v92
    v_swap_b32 v91, v93
    v_mfma_f32_16x16x32_bf16 v[208:211], v[24:27], v[80:83], 0
    buffer_load_dwordx4 v[164:167], v240, s[16:19], s54 offen offset:1024 sc1
    v_mfma_f32_16x16x32_bf16 v[212:215], v[24:27], v[84:87], 0
    v_mfma_f32_16x16x32_bf16 v[224:227], v[28:31], v[80:83], 0
    v_mfma_f32_16x16x32_bf16 v[228:231], v[28:31], v[84:87], 0
    s_add_u32 s54, s54, 88064
    buffer_load_dwordx4 v[168:171], v240, s[16:19], s54 offen offset:0 sc1
    v_mfma_f32_16x16x32_bf16 v[184:187], v[16:19], v[88:91], 0
    v_mfma_f32_16x16x32_bf16 v[188:191], v[16:19], v[92:95], 0
    v_mfma_f32_16x16x32_bf16 v[200:203], v[20:23], v[88:91], 0
    buffer_load_dwordx4 v[172:175], v240, s[16:19], s54 offen offset:1024 sc1
    s_add_u32 s71, s71, 1
    s_cmp_eq_u32 s71, 11
    s_cselect_b32 s71, 0, s71
    v_mfma_f32_16x16x32_bf16 v[204:207], v[20:23], v[92:95], 0
    v_mfma_f32_16x16x32_bf16 v[216:219], v[24:27], v[88:91], 0
    s_waitcnt vmcnt(18)
    v_swap_b32 v98, v100
    v_swap_b32 v99, v101
    v_mfma_f32_16x16x32_bf16 v[220:223], v[24:27], v[92:95], 0
    v_mfma_f32_16x16x32_bf16 v[232:235], v[28:31], v[88:91], 0
    v_mfma_f32_16x16x32_bf16 v[236:239], v[28:31], v[92:95], 0
    v_mfma_f32_16x16x32_bf16 v[176:179], v[32:35], v[96:99], v[176:179]
    s_cmp_ge_u32 s57, 7
    s_cbranch_scc1 g2ok_7
g2p_7:
    buffer_load_dword v10, v254, s[16:19], 0 offen sc1
    s_add_u32 s75, s75, 1
    s_waitcnt vmcnt(0)
    v_cmp_ne_u32 vcc, s70, v10
    s_cmp_ge_u32 s75, 65536
    s_cbranch_scc1 g2ok_7
    s_lshr_b32 s53, vcc_lo, 16
    s_or_b32 s53, s53, vcc_lo
    s_bitset1_b32 s53, 11
    s_ff1_i32_b32 s57, s53
    s_cmp_ge_u32 s57, 7
    s_cbranch_scc1 g2ok_7
    s_sleep 2
    s_branch g2p_7
g2ok_7:
    s_lshl_b32 s54, s71, 11
    s_add_u32 s54, s54, s73
    s_cmp_eq_u32 s71, s72
    s_cselect_b32 s54, 0x7f000000, s54
    buffer_load_dwordx4 v[80:83], v240, s[16:19], s54 offen offset:0 sc1
    v_mfma_f32_16x16x32_bf16 v[180:183], v[32:35], v[100:103], v[180:183]
    v_mfma_f32_16x16x32_bf16 v[192:195], v[36:39], v[96:99], v[192:195]
    v_mfma_f32_16x16x32_bf16 v[196:199], v[36:39], v[100:103], v[196:199]
    s_waitcnt vmcnt(17)
    v_swap_b32 v106, v108
    v_swap_b32 v107, v109
    v_mfma_f32_16x16x32_bf16 v[208:211], v[40:43], v[96:99], v[208:211]
    buffer_load_dwordx4 v[84:87], v240, s[16:19], s54 offen offset:1024 sc1
    v_mfma_f32_16x16x32_bf16 v[212:215], v[40:43], v[100:103], v[212:215]
    v_mfma_f32_16x16x32_bf16 v[224:227], v[44:47], v[96:99], v[224:227]
    v_mfma_f32_16x16x32_bf16 v[228:231], v[44:47], v[100:103], v[228:231]
    s_add_u32 s54, s54, 88064
    buffer_load_dwordx4 v[88:91], v240, s[16:19], s54 offen offset:0 sc1
    v_mfma_f32_16x16x32_bf16 v[184:187], v[32:35], v[104:107], v[184:187]
    v_mfma_f32_16x16x32_bf16 v[188:191], v[32:35], v[108:111], v[188:191]
    v_mfma_f32_16x16x32_bf16 v[200:203], v[36:39], v[104:107], v[200:203]
    buffer_load_dwordx4 v[92:95], v240, s[16:19], s54 offen offset:1024 sc1
    s_add_u32 s71, s71, 1
    s_cmp_eq_u32 s71, 11
    s_cselect_b32 s71, 0, s71
    v_mfma_f32_16x16x32_bf16 v[204:207], v[36:39], v[108:111], v[204:207]
    v_mfma_f32_16x16x32_bf16 v[216:219], v[40:43], v[104:107], v[216:219]
    s_waitcnt vmcnt(18)
    v_swap_b32 v114, v116
    v_swap_b32 v115, v117
    v_mfma_f32_16x16x32_bf16 v[220:223], v[40:43], v[108:111], v[220:223]
    v_mfma_f32_16x16x32_bf16 v[232:235], v[44:47], v[104:107], v[232:235]
    v_mfma_f32_16x16x32_bf16 v[236:239], v[44:47], v[108:111], v[236:239]
    v_mfma_f32_16x16x32_bf16 v[176:179], v[48:51], v[112:115], v[176:179]
    s_cmp_ge_u32 s57, 8
    s_cbranch_scc1 g2ok_8
g2p_8:
    buffer_load_dword v10, v254, s[16:19], 0 offen sc1
    s_add_u32 s75, s75, 1
    s_waitcnt vmcnt(0)
    v_cmp_ne_u32 vcc, s70, v10
    s_cmp_ge_u32 s75, 65536
    s_cbranch_scc1 g2ok_8
    s_lshr_b32 s53, vcc_lo, 16
    s_or_b32 s53, s53, vcc_lo
    s_bitset1_b32 s53, 11
    s_ff1_i32_b32 s57, s53
    s_cmp_ge_u32 s57, 8
    s_cbranch_scc1 g2ok_8
    s_sleep 2
    s_branch g2p_8
g2ok_8:
    s_lshl_b32 s54, s71, 11
    s_add_u32 s54, s54, s73
    s_cmp_eq_u32 s71, s72
    s_cselect_b32 s54, 0x7f000000, s54
    buffer_load_dwordx4 v[96:99], v240, s[16:19], s54 offen offset:0 sc1
    v_mfma_f32_16x16x32_bf16 v[180:183], v[48:51], v[116:119], v[180:183]
    v_mfma_f32_16x16x32_bf16 v[192:195], v[52:55], v[112:115], v[192:195]
    v_mfma_f32_16x16x32_bf16 v[196:199], v[52:55], v[116:119], v[196:199]
    s_waitcnt vmcnt(17)
    v_swap_b32 v122, v124
    v_swap_b32 v123, v125
    v_mfma_f32_16x16x32_bf16 v[208:211], v[56:59], v[112:115], v[208:211]
    buffer_load_dwordx4 v[100:103], v240, s[16:19], s54 offen offset:1024 sc1
    ds_read_b64_tr_b16 v[16:17], v242 offset:32768
    v_mfma_f32_16x16x32_bf16 v[212:215], v[56:59], v[116:119], v[212:215]
    ds_read_b64_tr_b16 v[18:19], v242 offset:34816
    v_mfma_f32_16x16x32_bf16 v[224:227], v[60:63], v[112:115], v[224:227]
    ds_read_b64_tr_b16 v[20:21], v243 offset:32768
    v_mfma_f32_16x16x32_bf16 v[228:231], v[60:63], v[116:119], v[228:231]
    s_add_u32 s54, s54, 88064
    buffer_load_dwordx4 v[104:107], v240, s[16:19], s54 offen offset:0 sc1
    ds_read_b64_tr_b16 v[22:23], v243 offset:34816
    v_mfma_f32_16x16x32_bf16 v[184:187], v[48:51], v[120:123], v[184:187]
    ds_read_b64_tr_b16 v[24:25], v244 offset:32768
    v_mfma_f32_16x16x32_bf16 v[188:191], v[48:51], v[124:127], v[188:191]
    ds_read_b64_tr_b16 v[26:27], v244 offset:34816
    v_mfma_f32_16x16x32_bf16 v[200:203], v[52:55], v[120:123], v[200:203]
    buffer_load_dwordx4 v[108:111], v240, s[16:19], s54 offen offset:1024 sc1
    s_add_u32 s71, s71, 1
    s_cmp_eq_u32 s71, 11
    s_cselect_b32 s71, 0, s71
    ds_read_b64_tr_b16 v[28:29], v245 offset:32768
    v_mfma_f32_16x16x32_bf16 v[204:207], v[52:55], v[124:127], v[204:207]
    ds_read_b64_tr_b16 v[30:31], v245 offset:34816
    v_mfma_f32_16x16x32_bf16 v[216:219], v[56:59], v[120:123], v[216:219]
    s_waitcnt vmcnt(18)
    v_swap_b32 v130, v132
    v_swap_b32 v131, v133
    v_mfma_f32_16x16x32_bf16 v[220:223], v[56:59], v[124:127], v[220:223]
    v_mfma_f32_16x16x32_bf16 v[232:235], v[60:63], v[120:123], v[232:235]
    v_mfma_f32_16x16x32_bf16 v[236:239], v[60:63], v[124:127], v[236:239]
    v_mfma_f32_16x16x32_bf16 v[176:179], v[64:67], v[128:131], v[176:179]
    s_cmp_ge_u32 s57, 9
    s_cbranch_scc1 g2ok_9
g2p_9:
    buffer_load_dword v10, v254, s[16:19], 0 offen sc1
    s_add_u32 s75, s75, 1
    s_waitcnt vmcnt(0)
    v_cmp_ne_u32 vcc, s70, v10
    s_cmp_ge_u32 s75, 65536
    s_cbranch_scc1 g2ok_9
    s_lshr_b32 s53, vcc_lo, 16
    s_or_b32 s53, s53, vcc_lo
    s_bitset1_b32 s53, 11
    s_ff1_i32_b32 s57, s53
    s_cmp_ge_u32 s57, 9
    s_cbranch_scc1 g2ok_9
    s_sleep 2
    s_branch g2p_9
g2ok_9:
    s_lshl_b32 s54, s71, 11
    s_add_u32 s54, s54, s73
    s_cmp_eq_u32 s71, s72
    s_cselect_b32 s54, 0x7f000000, s54
    buffer_load_dwordx4 v[112:115], v240, s[16:19], s54 offen offset:0 sc1
    v_mfma_f32_16x16x32_bf16 v[180:183], v[64:67], v[132:135], v[180:183]
    v_mfma_f32_16x16x32_bf16 v[192:195], v[68:71], v[128:131], v[192:195]
    v_mfma_f32_16x16x32_bf16 v[196:199], v[68:71], v[132:135], v[196:199]
    s_waitcnt vmcnt(17)
    v_swap_b32 v138, v140
    v_swap_b32 v139, v141
    v_mfma_f32_16x16x32_bf16 v[208:211], v[72:75], v[128:131], v[208:211]
    buffer_load_dwordx4 v[116:119], v240, s[16:19], s54 offen offset:1024 sc1
    ds_read_b64_tr_b16 v[32:33], v242 offset:49152
    v_mfma_f32_16x16x32_bf16 v[212:215], v[72:75], v[132:135], v[212:215]
    ds_read_b64_tr_b16 v[34:35], v242 offset:51200
    v_mfma_f32_16x16x32_bf16 v[224:227], v[76:79], v[128:131], v[224:227]
    ds_read_b64_tr_b16 v[36:37], v243 offset:49152
    v_mfma_f32_16x16x32_bf16 v[228:231], v[76:79], v[132:135], v[228:231]
    s_add_u32 s54, s54, 88064
    buffer_load_dwordx4 v[120:123], v240, s[16:19], s54 offen offset:0 sc1
    ds_read_b64_tr_b16 v[38:39], v243 offset:51200
    v_mfma_f32_16x16x32_bf16 v[184:187], v[64:67], v[136:139], v[184:187]
    ds_read_b64_tr_b16 v[40:41], v244 offset:49152
    v_mfma_f32_16x16x32_bf16 v[188:191], v[64:67], v[140:143], v[188:191]
    ds_read_b64_tr_b16 v[42:43], v244 offset:51200
    v_mfma_f32_16x16x32_bf16 v[200:203], v[68:71], v[136:139], v[200:203]
    buffer_load_dwordx4 v[124:127], v240, s[16:19], s54 offen offset:1024 sc1
    s_add_u32 s71, s71, 1
    s_cmp_eq_u32 s71, 11
    s_cselect_b32 s71, 0, s71
    ds_read_b64_tr_b16 v[44:45], v245 offset:49152
    v_mfma_f32_16x16x32_bf16 v[204:207], v[68:71], v[140:143], v[204:207]
    ds_read_b64_tr_b16 v[46:47], v245 offset:51200
    v_mfma_f32_16x16x32_bf16 v[216:219], v[72:75], v[136:139], v[216:219]
    s_waitcnt vmcnt(18)
    v_swap_b32 v146, v148
    v_swap_b32 v147, v149
    s_waitcnt lgkmcnt(8)
    v_mfma_f32_16x16x32_bf16 v[220:223], v[72:75], v[140:143], v[220:223]
    v_mfma_f32_16x16x32_bf16 v[232:235], v[76:79], v[136:139], v[232:235]
    v_mfma_f32_16x16x32_bf16 v[236:239], v[76:79], v[140:143], v[236:239]
    v_mfma_f32_16x16x32_bf16 v[176:179], v[16:19], v[144:147], v[176:179]
    s_cmp_ge_u32 s57, 10
    s_cbranch_scc1 g2ok_10
g2p_10:
    buffer_load_dword v10, v254, s[16:19], 0 offen sc1
    s_add_u32 s75, s75, 1
    s_waitcnt vmcnt(0)
    v_cmp_ne_u32 vcc, s70, v10
    s_cmp_ge_u32 s75, 65536
    s_cbranch_scc1 g2ok_10
    s_lshr_b32 s53, vcc_lo, 16
    s_or_b32 s53, s53, vcc_lo
    s_bitset1_b32 s53, 11
    s_ff1_i32_b32 s57, s53
    s_cmp_ge_u32 s57, 10
    s_cbranch_scc1 g2ok_10
    s_sleep 2
    s_branch g2p_10
g2ok_10:
    s_lshl_b32 s54, s71, 11
    s_add_u32 s54, s54, s73
    s_cmp_eq_u32 s71, s72
    s_cselect_b32 s54, 0x7f000000, s54
    buffer_load_dwordx4 v[128:131], v240, s[16:19], s54 offen offset:0 sc1
    v_mfma_f32_16x16x32_bf16 v[180:183], v[16:19], v[148:151], v[180:183]
    v_mfma_f32_16x16x32_bf16 v[192:195], v[20:23], v[144:147], v[192:195]
    v_mfma_f32_16x16x32_bf16 v[196:199], v[20:23], v[148:151], v[196:199]
    s_waitcnt vmcnt(17)
    v_swap_b32 v154, v156
    v_swap_b32 v155, v157
    v_mfma_f32_16x16x32_bf16 v[208:211], v[24:27], v[144:147], v[208:211]
    buffer_load_dwordx4 v[132:135], v240, s[16:19], s54 offen offset:1024 sc1
    ds_read_b64_tr_b16 v[48:49], v250 offset:0
    v_mfma_f32_16x16x32_bf16 v[212:215], v[24:27], v[148:151], v[212:215]
    ds_read_b64_tr_b16 v[50:51], v250 offset:2048
    v_mfma_f32_16x16x32_bf16 v[224:227], v[28:31], v[144:147], v[224:227]
    ds_read_b64_tr_b16 v[52:53], v251 offset:0
    v_mfma_f32_16x16x32_bf16 v[228:231], v[28:31], v[148:151], v[228:231]
    s_add_u32 s54, s54, 88064
    buffer_load_dwordx4 v[136:139], v240, s[16:19], s54 offen offset:0 sc1
    ds_read_b64_tr_b16 v[54:55], v251 offset:2048
    v_mfma_f32_16x16x32_bf16 v[184:187], v[16:19], v[152:155], v[184:187]
    ds_read_b64_tr_b16 v[56:57], v252 offset:0
    v_mfma_f32_16x16x32_bf16 v[188:191], v[16:19], v[156:159], v[188:191]
    ds_read_b64_tr_b16 v[58:59], v252 offset:2048
    v_mfma_f32_16x16x32_bf16 v[200:203], v[20:23], v[152:155], v[200:203]
    buffer_load_dwordx4 v[140:143], v240, s[16:19], s54 offen offset:1024 sc1
    s_add_u32 s71, s71, 1
    s_cmp_eq_u32 s71, 11
    s_cselect_b32 s71, 0, s71
    ds_read_b64_tr_b16 v[60:61], v253 offset:0
    v_mfma_f32_16x16x32_bf16 v[204:207], v[20:23], v[156:159], v[204:207]
    ds_read_b64_tr_b16 v[62:63], v253 offset:2048
    v_mfma_f32_16x16x32_bf16 v[216:219], v[24:27], v[152:155], v[216:219]
    s_waitcnt vmcnt(18)
    v_swap_b32 v162, v164
    v_swap_b32 v163, v165
    s_waitcnt lgkmcnt(8)
    v_mfma_f32_16x16x32_bf16 v[220:223], v[24:27], v[156:159], v[220:223]
    v_mfma_f32_16x16x32_bf16 v[232:235], v[28:31], v[152:155], v[232:235]
    v_mfma_f32_16x16x32_bf16 v[236:239], v[28:31], v[156:159], v[236:239]
    v_mfma_f32_16x16x32_bf16 v[176:179], v[32:35], v[160:163], v[176:179]
    s_cmp_ge_u32 s57, 11
    s_cbranch_scc1 g2ok_11
g2p_11:
    buffer_load_dword v10, v254, s[16:19], 0 offen sc1
    s_add_u32 s75, s75, 1
    s_waitcnt vmcnt(0)
    v_cmp_ne_u32 vcc, s70, v10
    s_cmp_ge_u32 s75, 65536
    s_cbranch_scc1 g2ok_11
    s_lshr_b32 s53, vcc_lo, 16
    s_or_b32 s53, s53, vcc_lo
    s_bitset1_b32 s53, 11
    s_ff1_i32_b32 s57, s53
    s_cmp_ge_u32 s57, 11
    s_cbranch_scc1 g2ok_11
    s_sleep 2
    s_branch g2p_11
g2ok_11:
    s_lshl_b32 s54, s71, 11
    s_add_u32 s54, s54, s73
    s_cmp_eq_u32 s71, s72
    s_cselect_b32 s54, 0x7f000000, s54
    buffer_load_dwordx4 v[144:147], v240, s[16:19], s54 offen offset:0 sc1
    v_mfma_f32_16x16x32_bf16 v[180:183], v[32:35], v[164:167], v[180:183]
    v_mfma_f32_16x16x32_bf16 v[192:195], v[36:39], v[160:163], v[192:195]
    v_mfma_f32_16x16x32_bf16 v[196:199], v[36:39], v[164:167], v[196:199]
    s_waitcnt vmcnt(17)
    v_swap_b32 v170, v172
    v_swap_b32 v171, v173
    v_mfma_f32_16x16x32_bf16 v[208:211], v[40:43], v[160:163], v[208:211]
    buffer_load_dwordx4 v[148:151], v240, s[16:19], s54 offen offset:1024 sc1
    ds_read_b64_tr_b16 v[64:65], v246 offset:0
    v_mfma_f32_16x16x32_bf16 v[212:215], v[40:43], v[164:167], v[212:215]
    ds_read_b64_tr_b16 v[66:67], v246 offset:2048
    v_mfma_f32_16x16x32_bf16 v[224:227], v[44:47], v[160:163], v[224:227]
    ds_read_b64_tr_b16 v[68:69], v247 offset:0
    v_mfma_f32_16x16x32_bf16 v[228:231], v[44:47], v[164:167], v[228:231]
    s_add_u32 s54, s54, 88064
    buffer_load_dwordx4 v[152:155], v240, s[16:19], s54 offen offset:0 sc1
    ds_read_b64_tr_b16 v[70:71], v247 offset:2048
    v_mfma_f32_16x16x32_bf16 v[184:187], v[32:35], v[168:171], v[184:187]
    ds_read_b64_tr_b16 v[72:73], v248 offset:0
    v_mfma_f32_16x16x32_bf16 v[188:191], v[32:35], v[172:175], v[188:191]
    ds_read_b64_tr_b16 v[74:75], v248 offset:2048
    v_mfma_f32_16x16x32_bf16 v[200:203], v[36:39], v[168:171], v[200:203]
    buffer_load_dwordx4 v[156:159], v240, s[16:19], s54 offen offset:1024 sc1
    s_add_u32 s71, s71, 1
    s_cmp_eq_u32 s71, 11
    s_cselect_b32 s71, 0, s71
    ds_read_b64_tr_b16 v[76:77], v249 offset:0
    v_mfma_f32_16x16x32_bf16 v[204:207], v[36:39], v[172:175], v[204:207]
    ds_read_b64_tr_b16 v[78:79], v249 offset:2048
    v_mfma_f32_16x16x32_bf16 v[216:219], v[40:43], v[168:171], v[216:219]
    s_waitcnt vmcnt(18)
    v_swap_b32 v82, v84
    v_swap_b32 v83, v85
    s_waitcnt lgkmcnt(8)
    v_mfma_f32_16x16x32_bf16 v[220:223], v[40:43], v[172:175], v[220:223]
    v_mfma_f32_16x16x32_bf16 v[232:235], v[44:47], v[168:171], v[232:235]
    v_mfma_f32_16x16x32_bf16 v[236:239], v[44:47], v[172:175], v[236:239]
    s_mov_b64 exec, 1
    ds_add_u32 v12, v13 offset:96
    s_mov_b64 exec, -1
    v_mfma_f32_16x16x32_bf16 v[176:179], v[48:51], v[80:83], v[176:179]
    v_mfma_f32_16x16x32_bf16 v[180:183], v[48:51], v[84:87], v[180:183]
    v_mfma_f32_16x16x32_bf16 v[192:195], v[52:55], v[80:83], v[192:195]
    v_mfma_f32_16x16x32_bf16 v[196:199], v[52:55], v[84:87], v[196:199]
    s_waitcnt vmcnt(16)
    v_swap_b32 v90, v92
    v_swap_b32 v91, v93
    v_mfma_f32_16x16x32_bf16 v[208:211], v[56:59], v[80:83], v[208:211]
    ds_read_b64_tr_b16 v[16:17], v246 offset:4096
    v_mfma_f32_16x16x32_bf16 v[212:215], v[56:59], v[84:87], v[212:215]
    ds_read_b64_tr_b16 v[18:19], v246 offset:6144
    v_mfma_f32_16x16x32_bf16 v[224:227], v[60:63], v[80:83], v[224:227]
    ds_read_b64_tr_b16 v[20:21], v247 offset:4096
    v_mfma_f32_16x16x32_bf16 v[228:231], v[60:63], v[84:87], v[228:231]
    ds_read_b64_tr_b16 v[22:23], v247 offset:6144
    v_mfma_f32_16x16x32_bf16 v[184:187], v[48:51], v[88:91], v[184:187]
    ds_read_b64_tr_b16 v[24:25], v248 offset:4096
    v_mfma_f32_16x16x32_bf16 v[188:191], v[48:51], v[92:95], v[188:191]
    ds_read_b64_tr_b16 v[26:27], v248 offset:6144
    v_mfma_f32_16x16x32_bf16 v[200:203], v[52:55], v[88:91], v[200:203]
    ds_read_b64_tr_b16 v[28:29], v249 offset:4096
    v_mfma_f32_16x16x32_bf16 v[204:207], v[52:55], v[92:95], v[204:207]
    ds_read_b64_tr_b16 v[30:31], v249 offset:6144
    v_mfma_f32_16x16x32_bf16 v[216:219], v[56:59], v[88:91], v[216:219]
    s_waitcnt vmcnt(14)
    v_swap_b32 v98, v100
    v_swap_b32 v99, v101
    s_waitcnt lgkmcnt(8)
    v_mfma_f32_16x16x32_bf16 v[220:223], v[56:59], v[92:95], v[220:223]
    v_mfma_f32_16x16x32_bf16 v[232:235], v[60:63], v[88:91], v[232:235]
    v_mfma_f32_16x16x32_bf16 v[236:239], v[60:63], v[92:95], v[236:239]
    v_mfma_f32_16x16x32_bf16 v[176:179], v[64:67], v[96:99], v[176:179]
    v_mfma_f32_16x16x32_bf16 v[180:183], v[64:67], v[100:103], v[180:183]
    v_mfma_f32_16x16x32_bf16 v[192:195], v[68:71], v[96:99], v[192:195]
    v_mfma_f32_16x16x32_bf16 v[196:199], v[68:71], v[100:103], v[196:199]
    s_waitcnt vmcnt(12)
    v_swap_b32 v106, v108
    v_swap_b32 v107, v109
    v_mfma_f32_16x16x32_bf16 v[208:211], v[72:75], v[96:99], v[208:211]
    ds_read_b64_tr_b16 v[32:33], v242 offset:0
    v_mfma_f32_16x16x32_bf16 v[212:215], v[72:75], v[100:103], v[212:215]
    ds_read_b64_tr_b16 v[34:35], v242 offset:2048
    v_mfma_f32_16x16x32_bf16 v[224:227], v[76:79], v[96:99], v[224:227]
    ds_read_b64_tr_b16 v[36:37], v243 offset:0
    v_mfma_f32_16x16x32_bf16 v[228:231], v[76:79], v[100:103], v[228:231]
    ds_read_b64_tr_b16 v[38:39], v243 offset:2048
    v_mfma_f32_16x16x32_bf16 v[184:187], v[64:67], v[104:107], v[184:187]
    ds_read_b64_tr_b16 v[40:41], v244 offset:0
    v_mfma_f32_16x16x32_bf16 v[188:191], v[64:67], v[108:111], v[188:191]
    ds_read_b64_tr_b16 v[42:43], v244 offset:2048
    v_mfma_f32_16x16x32_bf16 v[200:203], v[68:71], v[104:107], v[200:203]
    ds_read_b64_tr_b16 v[44:45], v245 offset:0
    v_mfma_f32_16x16x32_bf16 v[204:207], v[68:71], v[108:111], v[204:207]
    ds_read_b64_tr_b16 v[46:47], v245 offset:2048
    v_mfma_f32_16x16x32_bf16 v[216:219], v[72:75], v[104:107], v[216:219]
    s_waitcnt vmcnt(10)
    v_swap_b32 v114, v116
    v_swap_b32 v115, v117
    s_waitcnt lgkmcnt(8)
    v_mfma_f32_16x16x32_bf16 v[220:223], v[72:75], v[108:111], v[220:223]
    v_mfma_f32_16x16x32_bf16 v[232:235], v[76:79], v[104:107], v[232:235]
    v_mfma_f32_16x16x32_bf16 v[236:239], v[76:79], v[108:111], v[236:239]
    v_mfma_f32_16x16x32_bf16 v[176:179], v[16:19], v[112:115], v[176:179]
    v_mfma_f32_16x16x32_bf16 v[180:183], v[16:19], v[116:119], v[180:183]
    v_mfma_f32_16x16x32_bf16 v[192:195], v[20:23], v[112:115], v[192:195]
    v_mfma_f32_16x16x32_bf16 v[196:199], v[20:23], v[116:119], v[196:199]
    s_waitcnt vmcnt(8)
    v_swap_b32 v122, v124
    v_swap_b32 v123, v125
    v_mfma_f32_16x16x32_bf16 v[208:211], v[24:27], v[112:115], v[208:211]
    ds_read_b64_tr_b16 v[48:49], v242 offset:16384
    v_mfma_f32_16x16x32_bf16 v[212:215], v[24:27], v[116:119], v[212:215]
    ds_read_b64_tr_b16 v[50:51], v242 offset:18432
    v_mfma_f32_16x16x32_bf16 v[224:227], v[28:31], v[112:115], v[224:227]
    ds_read_b64_tr_b16 v[52:53], v243 offset:16384
    v_mfma_f32_16x16x32_bf16 v[228:231], v[28:31], v[116:119], v[228:231]
    ds_read_b64_tr_b16 v[54:55], v243 offset:18432
    v_mfma_f32_16x16x32_bf16 v[184:187], v[16:19], v[120:123], v[184:187]
    ds_read_b64_tr_b16 v[56:57], v244 offset:16384
    v_mfma_f32_16x16x32_bf16 v[188:191], v[16:19], v[124:127], v[188:191]
    ds_read_b64_tr_b16 v[58:59], v244 offset:18432
    v_mfma_f32_16x16x32_bf16 v[200:203], v[20:23], v[120:123], v[200:203]
    ds_read_b64_tr_b16 v[60:61], v245 offset:16384
    v_mfma_f32_16x16x32_bf16 v[204:207], v[20:23], v[124:127], v[204:207]
    ds_read_b64_tr_b16 v[62:63], v245 offset:18432
    v_mfma_f32_16x16x32_bf16 v[216:219], v[24:27], v[120:123], v[216:219]
    s_waitcnt vmcnt(6)
    v_swap_b32 v130, v132
    v_swap_b32 v131, v133
    s_waitcnt lgkmcnt(8)
    v_mfma_f32_16x16x32_bf16 v[220:223], v[24:27], v[124:127], v[220:223]
    v_mfma_f32_16x16x32_bf16 v[232:235], v[28:31], v[120:123], v[232:235]
    v_mfma_f32_16x16x32_bf16 v[236:239], v[28:31], v[124:127], v[236:239]
    v_mfma_f32_16x16x32_bf16 v[176:179], v[32:35], v[128:131], v[176:179]
    v_mfma_f32_16x16x32_bf16 v[180:183], v[32:35], v[132:135], v[180:183]
    v_mfma_f32_16x16x32_bf16 v[192:195], v[36:39], v[128:131], v[192:195]
    v_mfma_f32_16x16x32_bf16 v[196:199], v[36:39], v[132:135], v[196:199]
    s_waitcnt vmcnt(4)
    v_swap_b32 v138, v140
    v_swap_b32 v139, v141
    v_mfma_f32_16x16x32_bf16 v[208:211], v[40:43], v[128:131], v[208:211]
    v_mfma_f32_16x16x32_bf16 v[212:215], v[40:43], v[132:135], v[212:215]
    v_mfma_f32_16x16x32_bf16 v[224:227], v[44:47], v[128:131], v[224:227]
    v_mfma_f32_16x16x32_bf16 v[228:231], v[44:47], v[132:135], v[228:231]
    v_mfma_f32_16x16x32_bf16 v[184:187], v[32:35], v[136:139], v[184:187]
    v_mfma_f32_16x16x32_bf16 v[188:191], v[32:35], v[140:143], v[188:191]
    v_mfma_f32_16x16x32_bf16 v[200:203], v[36:39], v[136:139], v[200:203]
    v_mfma_f32_16x16x32_bf16 v[204:207], v[36:39], v[140:143], v[204:207]
    v_mfma_f32_16x16x32_bf16 v[216:219], v[40:43], v[136:139], v[216:219]
    s_waitcnt vmcnt(2)
    v_swap_b32 v146, v148
    v_swap_b32 v147, v149
    s_waitcnt lgkmcnt(0)
    v_mfma_f32_16x16x32_bf16 v[220:223], v[40:43], v[140:143], v[220:223]
    v_mfma_f32_16x16x32_bf16 v[232:235], v[44:47], v[136:139], v[232:235]
    v_mfma_f32_16x16x32_bf16 v[236:239], v[44:47], v[140:143], v[236:239]
    v_mfma_f32_16x16x32_bf16 v[176:179], v[48:51], v[144:147], v[176:179]
    v_mfma_f32_16x16x32_bf16 v[180:183], v[48:51], v[148:151], v[180:183]
    v_mfma_f32_16x16x32_bf16 v[192:195], v[52:55], v[144:147], v[192:195]
    v_mfma_f32_16x16x32_bf16 v[196:199], v[52:55], v[148:151], v[196:199]
    s_waitcnt vmcnt(0)
    v_swap_b32 v154, v156
    v_swap_b32 v155, v157
    v_mfma_f32_16x16x32_bf16 v[208:211], v[56:59], v[144:147], v[208:211]
    v_mfma_f32_16x16x32_bf16 v[212:215], v[56:59], v[148:151], v[212:215]
    v_mfma_f32_16x16x32_bf16 v[224:227], v[60:63], v[144:147], v[224:227]
    v_mfma_f32_16x16x32_bf16 v[228:231], v[60:63], v[148:151], v[228:231]
    v_mfma_f32_16x16x32_bf16 v[184:187], v[48:51], v[152:155], v[184:187]
    v_mfma_f32_16x16x32_bf16 v[188:191], v[48:51], v[156:159], v[188:191]
    v_mfma_f32_16x16x32_bf16 v[200:203], v[52:55], v[152:155], v[200:203]
    v_mfma_f32_16x16x32_bf16 v[204:207], v[52:55], v[156:159], v[204:207]
    v_mfma_f32_16x16x32_bf16 v[216:219], v[56:59], v[152:155], v[216:219]
    v_mfma_f32_16x16x32_bf16 v[220:223], v[56:59], v[156:159], v[220:223]
    v_mfma_f32_16x16x32_bf16 v[232:235], v[60:63], v[152:155], v[232:235]
    v_mfma_f32_16x16x32_bf16 v[236:239], v[60:63], v[156:159], v[236:239]
    v_and_b32 v8, 15, v0
    v_lshrrev_b32 v9, 4, v0
    v_and_b32 v10, 7, v0
    v_xor_b32 v9, v9, v10
    v_lshlrev_b32 v9, 4, v9
    v_lshl_add_u32 v8, v8, 8, v9
    v_add_u32 v8, s59, v8
    v_xor_b32 v9, 64, v8
    s_nop 0
    ds_write_b128 v8, v[176:179] offset:0
    ds_write_b128 v8, v[180:183] offset:16384
    ds_write_b128 v8, v[184:187] offset:32768
    ds_write_b128 v8, v[188:191] offset:49152
    ds_write_b128 v9, v[192:195] offset:0
    ds_write_b128 v9, v[196:199] offset:16384
    ds_write_b128 v9, v[200:203] offset:32768
    ds_write_b128 v9, v[204:207] offset:49152
    ds_write_b128 v8, v[208:211] offset:128
    ds_write_b128 v8, v[212:215] offset:16512
    ds_write_b128 v8, v[216:219] offset:32896
    ds_write_b128 v8, v[220:223] offset:49280
    ds_write_b128 v9, v[224:227] offset:128
    ds_write_b128 v9, v[228:231] offset:16512
    ds_write_b128 v9, v[232:235] offset:32896
    ds_write_b128 v9, v[236:239] offset:49280
    s_waitcnt lgkmcnt(0)
    s_barrier
    s_lshl_b32 s53, s2, 3
    s_add_u32 s53, s53, s48
    s_cmp_lg_u32 s53, 0
    s_cbranch_scc1 ep_skip_20
    s_mov_b32 s75, 0
ep_top_21:
    v_xor_b32 v2, s70, v2
    v_xor_b32 v3, s70, v3
    v_xor_b32 v4, s70, v4
    v_xor_b32 v5, s70, v5
    v_or_b32 v2, v2, v3
    v_or_b32 v4, v4, v5
    v_or_b32 v2, v2, v4
    v_cmp_ne_u32 vcc, 0, v2
    s_cbranch_vccz ep_ok_22
    s_add_u32 s75, s75, 1
    s_cmp_ge_u32 s75, 65536
    s_cbranch_scc1 ep_ok_22
    v_lshlrev_b32 v6, 7, v0
    s_mov_b32 s53, 0xa80000
    buffer_load_dword v2, v6, s[16:19], s53 offen sc1
    s_add_u32 s53, s53, 8192
    buffer_load_dword v3, v6, s[16:19], s53 offen sc1
    s_add_u32 s53, s53, 8192
    buffer_load_dword v4, v6, s[16:19], s53 offen sc1
    s_add_u32 s53, s53, 8192
    buffer_load_dword v5, v6, s[16:19], s53 offen sc1
    s_add_u32 s53, s53, 8192
    s_waitcnt vmcnt(0)
    s_branch ep_top_21
ep_ok_22:
    s_mov_b32 s53, 0xae0000
    v_mov_b32 v8, s70
    v_mov_b32 v9, 0
    s_mov_b64 exec, 1
    buffer_store_dword v8, v9, s[16:19], s53 offen sc1
    s_mov_b64 exec, -1
ep_skip_20:
    s_endpgm
    .p2align 6
L_load:
    s_load_dwordx2 s[8:9], s[0:1], 56
    s_load_dwordx2 s[12:13], s[0:1], 64
    s_load_dwordx2 s[20:21], s[0:1], 8
    s_load_dwordx2 s[24:25], s[0:1], 16
    s_load_dwordx2 s[28:29], s[0:1], 24
    s_load_dwordx2 s[32:33], s[0:1], 72
    s_load_dwordx2 s[36:37], s[0:1], 80
    s_load_dwordx2 s[40:41], s[0:1], 32
    s_load_dwordx2 s[44:45], s[0:1], 40
    s_mov_b32 s6, 0x200000
    s_mov_b32 s7, 0x20000
    s_mov_b32 s10, 0x158000
    s_mov_b32 s11, 0x20000
    s_mov_b32 s14, 0x158000
    s_mov_b32 s15, 0x20000
    s_mov_b32 s18, 0x1500000
    s_mov_b32 s19, 0x20000
    s_mov_b32 s22, 0x200000
    s_mov_b32 s23, 0x20000
    s_mov_b32 s26, 0x200000
    s_mov_b32 s27, 0x20000
    s_mov_b32 s30, 0x1000
    s_mov_b32 s31, 0x20000
    s_mov_b32 s34, 0x158000
    s_mov_b32 s35, 0x20000
    s_mov_b32 s38, 0x200000
    s_mov_b32 s39, 0x20000
    s_mov_b32 s42, 0x200000
    s_mov_b32 s43, 0x20000
    s_and_b32 s53, s2, 1
    s_lshl_b32 s53, s53, 3
    s_bfe_u32 s54, s2, 0x30003
    s_add_u32 s49, s53, s54
    s_bfe_u32 s53, s2, 0x20001
    s_lshl_b32 s53, s53, 2
    s_lshr_b32 s55, s2, 6
    s_add_u32 s50, s53, s55
    s_mov_b32 s46, 0xd951c840
    s_mov_b32 s47, 0xea62fb73
    s_lshl_b32 s50, s50, 2
    s_lshr_b64 s[46:47], s[46:47], s50
    s_and_b32 s50, s46, 15
    s_mul_i32 s51, s50, 3
    s_lshr_b32 s53, s50, 2
    s_sub_u32 s51, s51, s53
    s_cmp_eq_u32 s50, 15
    s_subb_u32 s51, s51, 0
    s_bitcmp1_b32 0xc888, s50
    s_cselect_b32 s52, 2, 3
    s_and_b32 s64, s48, 3
    s_and_b32 s53, s48, 1
    s_lshl_b32 s53, s53, 2
    v_lshrrev_b32 v5, 4, v0
    v_add_u32 v5, s53, v5
    v_and_b32 v6, 7, v0
    v_xor_b32 v5, v5, v6
    v_lshlrev_b32 v5, 4, v5
    v_lshrrev_b32 v6, 3, v0
    v_lshl_add_u32 v14, v6, 10, v5
    v_lshrrev_b32 v5, 5, v0
    v_lshlrev_b32 v5, 1, v5
    v_and_b32 v6, 3, v0
    v_xor_b32 v5, v5, v6
    v_lshlrev_b32 v5, 4, v5
    v_lshrrev_b32 v6, 2, v0
    v_mul_u32_u24 v6, 2752, v6
    v_add_u32 v15, v6, v5
    s_lshl_b32 s67, s49, 4
    s_add_u32 s67, s67, s50
    s_and_b32 s53, s2, 1
    s_lshl_b32 s53, s53, 4
    s_and_b32 s54, s2, 6
    s_lshl_b32 s54, s54, 1
    s_add_u32 s53, s53, s54
    s_bfe_u32 s54, s2, 0x20003
    s_add_u32 s68, s53, s54
    s_lshr_b32 s69, s2, 5
    s_mov_b32 s75, 0
    s_mov_b32 s66, 0
    v_lshlrev_b32 v4, 4, v0
    v_mov_b32 v252, 138752
    v_mov_b32 v253, 1
    s_mov_b32 s76, 0xffff0000
    s_waitcnt lgkmcnt(0)
    s_barrier
    s_setprio 2
    s_lshl_b32 s60, s49, 17
    s_lshl_b32 s61, s51, 6
    s_cmp_eq_u32 s52, 3
    s_cselect_b32 s62, s61, 0x7f000000
    s_lshl_b32 s53, s64, 6
    v_xor_b32 v14, s53, v14
    v_xor_b32 v18, 64, v14
    s_add_u32 s57, s64, 1
    s_mul_i32 s58, s57, 40960
    s_mov_b32 s65, s64
    s_lshl_b32 s53, s64, 2
    s_add_u32 s53, s53, 138784
    v_mov_b32 v10, s53
lw_23:
    ds_read_b32 v20, v252 offset:64
    s_waitcnt lgkmcnt(0)
    s_nop 0
    v_readfirstlane_b32 s53, v20
    s_nop 0
    s_cmp_ge_u32 s53, s64
    s_cbranch_scc1 lw_ok_24
    s_sleep 1
    s_add_u32 s75, s75, 1
    s_cmp_lt_u32 s75, 4194304
    s_cbranch_scc1 lw_23
lw_ok_24:
ld_loop:
    s_add_u32 s54, s66, s57
    s_and_b32 s54, s54, 7
    s_lshl_b32 s53, s54, 7
    s_add_u32 s53, s53, s60
    s_mul_i32 s54, s54, 176128
    s_add_u32 s73, s61, s54
    s_add_u32 s74, s62, s54
    s_add_u32 m0, s58, 0
    s_nop 0
    buffer_load_dwordx4 v14, s[4:7], s53 offen  lds
    s_add_u32 m0, s58, 1024
    s_add_u32 s53, s53, 8192
    buffer_load_dwordx4 v18, s[4:7], s53 offen  lds
    s_add_u32 m0, s58, 2048
    s_add_u32 s53, s53, 8192
    buffer_load_dwordx4 v14, s[4:7], s53 offen  lds
    s_add_u32 m0, s58, 3072
    s_add_u32 s53, s53, 8192
    buffer_load_dwordx4 v18, s[4:7], s53 offen  lds
    s_add_u32 m0, s58, 4096
    s_add_u32 s53, s53, 8192
    buffer_load_dwordx4 v14, s[4:7], s53 offen  lds
    s_add_u32 m0, s58, 5120
    s_add_u32 s53, s53, 8192
    buffer_load_dwordx4 v18, s[4:7], s53 offen  lds
    s_add_u32 m0, s58, 6144
    s_add_u32 s53, s53, 8192
    buffer_load_dwordx4 v14, s[4:7], s53 offen  lds
    s_add_u32 m0, s58, 7168
    s_add_u32 s53, s53, 8192
    buffer_load_dwordx4 v18, s[4:7], s53 offen  lds
    s_add_u32 m0, s58, 8192
    s_add_u32 s53, s53, 8192
    buffer_load_dwordx4 v14, s[4:7], s53 offen  lds
    s_add_u32 m0, s58, 9216
    s_add_u32 s53, s53, 8192
    buffer_load_dwordx4 v18, s[4:7], s53 offen  lds
    s_add_u32 m0, s58, 10240
    s_add_u32 s53, s53, 8192
    buffer_load_dwordx4 v14, s[4:7], s53 offen  lds
    s_add_u32 m0, s58, 11264
    s_add_u32 s53, s53, 8192
    buffer_load_dwordx4 v18, s[4:7], s53 offen  lds
    s_add_u32 m0, s58, 12288
    s_add_u32 s53, s53, 8192
    buffer_load_dwordx4 v14, s[4:7], s53 offen  lds
    s_add_u32 m0, s58, 13312
    s_add_u32 s53, s53, 8192
    buffer_load_dwordx4 v18, s[4:7], s53 offen  lds
    s_add_u32 m0, s58, 14336
    s_add_u32 s53, s53, 8192
    buffer_load_dwordx4 v14, s[4:7], s53 offen  lds
    s_add_u32 m0, s58, 15360
    s_add_u32 s53, s53, 8192
    buffer_load_dwordx4 v18, s[4:7], s53 offen  lds
    s_add_u32 m0, s58, 16384
    s_nop 0
    buffer_load_dwordx4 v15, s[8:11], s73 offen offset:0  lds
    s_add_u32 m0, s58, 28672
    s_nop 0
    buffer_load_dwordx4 v15, s[12:15], s73 offen offset:0  lds
    s_add_u32 m0, s58, 20416
    s_nop 0
    buffer_load_dwordx4 v15, s[8:11], s73 offen offset:64  lds
    s_add_u32 m0, s58, 32704
    s_nop 0
    buffer_load_dwordx4 v15, s[12:15], s73 offen offset:64  lds
    s_add_u32 m0, s58, 24448
    s_nop 0
    buffer_load_dwordx4 v15, s[8:11], s74 offen offset:128  lds
    s_add_u32 m0, s58, 36736
    s_nop 0
    buffer_load_dwordx4 v15, s[12:15], s74 offen offset:128  lds
    s_add_u32 s73, s73, 44032
    s_add_u32 s74, s74, 44032
    s_add_u32 m0, s58, 17408
    s_nop 0
    buffer_load_dwordx4 v15, s[8:11], s73 offen offset:0  lds
    s_add_u32 m0, s58, 29696
    s_nop 0
    buffer_load_dwordx4 v15, s[12:15], s73 offen offset:0  lds
    s_add_u32 m0, s58, 21440
    s_nop 0
    buffer_load_dwordx4 v15, s[8:11], s73 offen offset:64  lds
    s_add_u32 m0, s58, 33728
    s_nop 0
    buffer_load_dwordx4 v15, s[12:15], s73 offen offset:64  lds
    s_add_u32 m0, s58, 25472
    s_nop 0
    buffer_load_dwordx4 v15, s[8:11], s74 offen offset:128  lds
    s_add_u32 m0, s58, 37760
    s_nop 0
    buffer_load_dwordx4 v15, s[12:15], s74 offen offset:128  lds
    s_add_u32 s73, s73, 44032
    s_add_u32 s74, s74, 44032
    s_add_u32 m0, s58, 18432
    s_nop 0
    buffer_load_dwordx4 v15, s[8:11], s73 offen offset:0  lds
    s_add_u32 m0, s58, 30720
    s_nop 0
    buffer_load_dwordx4 v15, s[12:15], s73 offen offset:0  lds
    s_add_u32 m0, s58, 22464
    s_nop 0
    buffer_load_dwordx4 v15, s[8:11], s73 offen offset:64  lds
    s_add_u32 m0, s58, 34752
    s_nop 0
    buffer_load_dwordx4 v15, s[12:15], s73 offen offset:64  lds
    s_add_u32 m0, s58, 26496
    s_nop 0
    buffer_load_dwordx4 v15, s[8:11], s74 offen offset:128  lds
    s_add_u32 m0, s58, 38784
    s_nop 0
    buffer_load_dwordx4 v15, s[12:15], s74 offen offset:128  lds
    s_add_u32 s73, s73, 44032
    s_add_u32 s74, s74, 44032
    s_add_u32 m0, s58, 19456
    s_nop 0
    buffer_load_dwordx4 v15, s[8:11], s73 offen offset:0  lds
    s_add_u32 m0, s58, 31744
    s_nop 0
    buffer_load_dwordx4 v15, s[12:15], s73 offen offset:0  lds
    s_add_u32 m0, s58, 23488
    s_nop 0
    buffer_load_dwordx4 v15, s[8:11], s73 offen offset:64  lds
    s_add_u32 m0, s58, 35776
    s_nop 0
    buffer_load_dwordx4 v15, s[12:15], s73 offen offset:64  lds
    s_add_u32 m0, s58, 27520
    s_nop 0
    buffer_load_dwordx4 v15, s[8:11], s74 offen offset:128  lds
    s_add_u32 m0, s58, 39808
    s_nop 0
    buffer_load_dwordx4 v15, s[12:15], s74 offen offset:128  lds
    v_mov_b32 v16, s57
    s_mov_b64 exec, 1
    ds_max_u32 v252, v16 offset:64
    s_mov_b64 exec, -1
    s_sub_u32 s58, s58, 40960
    s_cselect_b32 s58, 81920, s58
    s_cmp_ge_u32 s57, 6
    s_cbranch_scc1 ld_done
    s_waitcnt vmcnt(0)
    ds_write_b32 v10, v16
lw_25:
    ds_read_b128 v[20:23], v252 offset:16
    s_waitcnt lgkmcnt(0)
    v_min3_u32 v20, v20, v21, v22
    v_min_u32 v20, v20, v23
    s_nop 0
    v_readfirstlane_b32 s53, v20
    s_nop 0
    s_cmp_ge_u32 s53, s57
    s_cbranch_scc1 lw_ok_26
    s_sleep 1
    s_add_u32 s75, s75, 1
    s_cmp_lt_u32 s75, 4194304
    s_cbranch_scc1 lw_25
lw_ok_26:
    s_add_u32 s57, s57, 2
    s_branch ld_loop
ld_done:
    v_lshrrev_b32 v12, 4, v0
    v_lshlrev_b32 v13, 1, v12
    v_and_b32 v14, 7, v0
    v_xor_b32 v13, v13, v14
    v_lshlrev_b32 v13, 4, v13
    v_lshrrev_b32 v14, 3, v0
    v_lshl_add_u32 v241, v14, 10, v13
    s_lshl_b32 s59, s64, 12
    s_lshl_b32 s101, s64, 13
    s_add_u32 s63, s101, 147456
    s_add_u32 s101, s101, 131072
    s_cmp_eq_u32 s64, 0
    s_cselect_b32 s101, 127488, s101
    s_mov_b32 s53, 0
    s_add_u32 s3, s53, 0
    s_sub_u32 s54, s3, 11
    s_cmp_ge_u32 s3, 11
    s_cselect_b32 s3, s54, s3
    s_mul_i32 s74, s64, 360448
    s_lshl_b32 s54, s69, 7
    s_add_u32 s74, s74, s54
    s_lshl_b32 s53, s64, 2
    v_add_u32 v11, s53, v252
    v_mov_b32 v17, 2
    s_waitcnt vmcnt(0)
    ds_write_b32 v10, v16
lw_27:
    ds_read_b32 v20, v252 offset:64
    s_waitcnt lgkmcnt(0)
    s_nop 0
    v_readfirstlane_b32 s53, v20
    s_nop 0
    s_cmp_ge_u32 s53, 7
    s_cbranch_scc1 lw_ok_28
    s_sleep 1
    s_add_u32 s75, s75, 1
    s_cmp_lt_u32 s75, 4194304
    s_cbranch_scc1 lw_27
lw_ok_28:
lw_29:
    ds_read_b32 v20, v252 offset:12
    s_waitcnt lgkmcnt(0)
    s_nop 0
    v_readfirstlane_b32 s53, v20
    s_nop 0
    s_cmp_ge_u32 s53, 2
    s_cbranch_scc1 lw_ok_30
    s_sleep 1
    s_add_u32 s75, s75, 1
    s_cmp_lt_u32 s75, 4194304
    s_cbranch_scc1 lw_29
lw_ok_30:
    s_lshl_b32 s56, s3, 15
    s_add_u32 s56, s56, s74
    s_add_u32 m0, s101, 0
    s_nop 0
    buffer_load_dwordx4 v241, s[32:35], s56 offen  lds
    s_add_u32 m0, s101, 1024
    s_add_u32 s56, s56, 8192
    buffer_load_dwordx4 v241, s[32:35], s56 offen  lds
    s_add_u32 m0, s101, 2048
    s_add_u32 s56, s56, 8192
    buffer_load_dwordx4 v241, s[32:35], s56 offen  lds
    s_add_u32 m0, s101, 3072
    s_add_u32 s56, s56, 8192
    buffer_load_dwordx4 v241, s[32:35], s56 offen  lds
    s_add_u32 m0, s63, 0
    s_add_u32 s56, s56, 696320
    buffer_load_dwordx4 v241, s[32:35], s56 offen  lds
    s_add_u32 m0, s63, 1024
    s_add_u32 s56, s56, 8192
    buffer_load_dwordx4 v241, s[32:35], s56 offen  lds
    s_add_u32 m0, s63, 2048
    s_add_u32 s56, s56, 8192
    buffer_load_dwordx4 v241, s[32:35], s56 offen  lds
    s_add_u32 m0, s63, 3072
    s_add_u32 s56, s56, 8192
    buffer_load_dwordx4 v241, s[32:35], s56 offen  lds
    s_add_u32 s3, s3, 1
    s_cmp_eq_u32 s3, 11
    s_cselect_b32 s3, 0, s3
    s_lshl_b32 s56, s3, 15
    s_add_u32 s56, s56, s74
    s_add_u32 m0, s101, 4096
    s_nop 0
    buffer_load_dwordx4 v241, s[32:35], s56 offen  lds
    s_add_u32 m0, s101, 5120
    s_add_u32 s56, s56, 8192
    buffer_load_dwordx4 v241, s[32:35], s56 offen  lds
    s_add_u32 m0, s101, 6144
    s_add_u32 s56, s56, 8192
    buffer_load_dwordx4 v241, s[32:35], s56 offen  lds
    s_add_u32 m0, s101, 7168
    s_add_u32 s56, s56, 8192
    buffer_load_dwordx4 v241, s[32:35], s56 offen  lds
    s_add_u32 m0, s63, 4096
    s_add_u32 s56, s56, 696320
    buffer_load_dwordx4 v241, s[32:35], s56 offen  lds
    s_add_u32 m0, s63, 5120
    s_add_u32 s56, s56, 8192
    buffer_load_dwordx4 v241, s[32:35], s56 offen  lds
    s_add_u32 m0, s63, 6144
    s_add_u32 s56, s56, 8192
    buffer_load_dwordx4 v241, s[32:35], s56 offen  lds
    s_add_u32 m0, s63, 7168
    s_add_u32 s56, s56, 8192
    buffer_load_dwordx4 v241, s[32:35], s56 offen  lds
    s_add_u32 s3, s3, 1
    s_cmp_eq_u32 s3, 11
    s_cselect_b32 s3, 0, s3
lw_31:
    ds_read_b128 v[20:23], v252 offset:16
    s_waitcnt lgkmcnt(0)
    v_min3_u32 v20, v20, v21, v22
    v_min_u32 v20, v20, v23
    s_nop 0
    v_readfirstlane_b32 s53, v20
    s_nop 0
    s_cmp_ge_u32 s53, 7
    s_cbranch_scc1 lw_ok_32
    s_sleep 1
    s_add_u32 s75, s75, 1
    s_cmp_lt_u32 s75, 4194304
    s_cbranch_scc1 lw_31
lw_ok_32:
    s_lshl_b32 s56, s3, 15
    s_add_u32 s56, s56, s74
    s_add_u32 m0, s59, 0
    s_nop 0
    buffer_load_dwordx4 v241, s[32:35], s56 offen  lds
    s_add_u32 m0, s59, 1024
    s_add_u32 s56, s56, 8192
    buffer_load_dwordx4 v241, s[32:35], s56 offen  lds
    s_add_u32 m0, s59, 2048
    s_add_u32 s56, s56, 8192
    buffer_load_dwordx4 v241, s[32:35], s56 offen  lds
    s_add_u32 m0, s59, 3072
    s_add_u32 s56, s56, 8192
    buffer_load_dwordx4 v241, s[32:35], s56 offen  lds
    s_add_u32 m0, s59, 8192
    s_add_u32 s56, s56, 696320
    buffer_load_dwordx4 v241, s[32:35], s56 offen  lds
    s_add_u32 m0, s59, 9216
    s_add_u32 s56, s56, 8192
    buffer_load_dwordx4 v241, s[32:35], s56 offen  lds
    s_add_u32 m0, s59, 10240
    s_add_u32 s56, s56, 8192
    buffer_load_dwordx4 v241, s[32:35], s56 offen  lds
    s_add_u32 m0, s59, 11264
    s_add_u32 s56, s56, 8192
    buffer_load_dwordx4 v241, s[32:35], s56 offen  lds
    s_add_u32 s3, s3, 1
    s_cmp_eq_u32 s3, 11
    s_cselect_b32 s3, 0, s3
    s_lshl_b32 s56, s3, 15
    s_add_u32 s56, s56, s74
    s_add_u32 m0, s59, 16384
    s_nop 0
    buffer_load_dwordx4 v241, s[32:35], s56 offen  lds
    s_add_u32 m0, s59, 17408
    s_add_u32 s56, s56, 8192
    buffer_load_dwordx4 v241, s[32:35], s56 offen  lds
    s_add_u32 m0, s59, 18432
    s_add_u32 s56, s56, 8192
    buffer_load_dwordx4 v241, s[32:35], s56 offen  lds
    s_add_u32 m0, s59, 19456
    s_add_u32 s56, s56, 8192
    buffer_load_dwordx4 v241, s[32:35], s56 offen  lds
    s_add_u32 m0, s59, 24576
    s_add_u32 s56, s56, 696320
    buffer_load_dwordx4 v241, s[32:35], s56 offen  lds
    s_add_u32 m0, s59, 25600
    s_add_u32 s56, s56, 8192
    buffer_load_dwordx4 v241, s[32:35], s56 offen  lds
    s_add_u32 m0, s59, 26624
    s_add_u32 s56, s56, 8192
    buffer_load_dwordx4 v241, s[32:35], s56 offen  lds
    s_add_u32 m0, s59, 27648
    s_add_u32 s56, s56, 8192
    buffer_load_dwordx4 v241, s[32:35], s56 offen  lds
    s_add_u32 s3, s3, 1
    s_cmp_eq_u32 s3, 11
    s_cselect_b32 s3, 0, s3
    s_waitcnt vmcnt(16)
    ds_write_b32 v11, v253 offset:80
lw_33:
    ds_read_b128 v[20:23], v252 offset:16
    s_waitcnt lgkmcnt(0)
    v_min3_u32 v20, v20, v21, v22
    v_min_u32 v20, v20, v23
    s_nop 0
    v_readfirstlane_b32 s53, v20
    s_nop 0
    s_cmp_ge_u32 s53, 8
    s_cbranch_scc1 lw_ok_34
    s_sleep 1
    s_add_u32 s75, s75, 1
    s_cmp_lt_u32 s75, 4194304
    s_cbranch_scc1 lw_33
lw_ok_34:
    s_lshl_b32 s56, s3, 15
    s_add_u32 s56, s56, s74
    s_add_u32 m0, s59, 32768
    s_nop 0
    buffer_load_dwordx4 v241, s[32:35], s56 offen  lds
    s_add_u32 m0, s59, 33792
    s_add_u32 s56, s56, 8192
    buffer_load_dwordx4 v241, s[32:35], s56 offen  lds
    s_add_u32 m0, s59, 34816
    s_add_u32 s56, s56, 8192
    buffer_load_dwordx4 v241, s[32:35], s56 offen  lds
    s_add_u32 m0, s59, 35840
    s_add_u32 s56, s56, 8192
    buffer_load_dwordx4 v241, s[32:35], s56 offen  lds
    s_waitcnt vmcnt(4)
    s_add_u32 m0, s59, 40960
    s_add_u32 s56, s56, 696320
    buffer_load_dwordx4 v241, s[32:35], s56 offen  lds
    s_add_u32 m0, s59, 41984
    s_add_u32 s56, s56, 8192
    buffer_load_dwordx4 v241, s[32:35], s56 offen  lds
    s_add_u32 m0, s59, 43008
    s_add_u32 s56, s56, 8192
    buffer_load_dwordx4 v241, s[32:35], s56 offen  lds
    s_add_u32 m0, s59, 44032
    s_add_u32 s56, s56, 8192
    buffer_load_dwordx4 v241, s[32:35], s56 offen  lds
    s_add_u32 s3, s3, 1
    s_cmp_eq_u32 s3, 11
    s_cselect_b32 s3, 0, s3
    s_waitcnt vmcnt(8)
    ds_write_b32 v11, v17 offset:80
    s_lshl_b32 s56, s3, 15
    s_add_u32 s56, s56, s74
    s_add_u32 m0, s59, 49152
    s_nop 0
    buffer_load_dwordx4 v241, s[32:35], s56 offen  lds
    s_add_u32 m0, s59, 50176
    s_add_u32 s56, s56, 8192
    buffer_load_dwordx4 v241, s[32:35], s56 offen  lds
    s_add_u32 m0, s59, 51200
    s_add_u32 s56, s56, 8192
    buffer_load_dwordx4 v241, s[32:35], s56 offen  lds
    s_add_u32 m0, s59, 52224
    s_add_u32 s56, s56, 8192
    buffer_load_dwordx4 v241, s[32:35], s56 offen  lds
    s_waitcnt vmcnt(8)
    s_add_u32 m0, s59, 57344
    s_add_u32 s56, s56, 696320
    buffer_load_dwordx4 v241, s[32:35], s56 offen  lds
    s_add_u32 m0, s59, 58368
    s_add_u32 s56, s56, 8192
    buffer_load_dwordx4 v241, s[32:35], s56 offen  lds
    s_add_u32 m0, s59, 59392
    s_add_u32 s56, s56, 8192
    buffer_load_dwordx4 v241, s[32:35], s56 offen  lds
    s_add_u32 m0, s59, 60416
    s_add_u32 s56, s56, 8192
    buffer_load_dwordx4 v241, s[32:35], s56 offen  lds
    s_add_u32 s3, s3, 1
    s_cmp_eq_u32 s3, 11
    s_cselect_b32 s3, 0, s3
    s_waitcnt vmcnt(8)
    s_lshl_b32 s56, s3, 15
    s_add_u32 s56, s56, s74
    s_add_u32 m0, s59, 65536
    s_nop 0
    buffer_load_dwordx4 v241, s[32:35], s56 offen  lds
    s_add_u32 m0, s59, 66560
    s_add_u32 s56, s56, 8192
    buffer_load_dwordx4 v241, s[32:35], s56 offen  lds
    s_add_u32 m0, s59, 67584
    s_add_u32 s56, s56, 8192
    buffer_load_dwordx4 v241, s[32:35], s56 offen  lds
    s_add_u32 m0, s59, 68608
    s_add_u32 s56, s56, 8192
    buffer_load_dwordx4 v241, s[32:35], s56 offen  lds
    s_waitcnt vmcnt(8)
    s_add_u32 m0, s59, 73728
    s_add_u32 s56, s56, 696320
    buffer_load_dwordx4 v241, s[32:35], s56 offen  lds
    s_add_u32 m0, s59, 74752
    s_add_u32 s56, s56, 8192
    buffer_load_dwordx4 v241, s[32:35], s56 offen  lds
    s_add_u32 m0, s59, 75776
    s_add_u32 s56, s56, 8192
    buffer_load_dwordx4 v241, s[32:35], s56 offen  lds
    s_add_u32 m0, s59, 76800
    s_add_u32 s56, s56, 8192
    buffer_load_dwordx4 v241, s[32:35], s56 offen  lds
    s_add_u32 s3, s3, 1
    s_cmp_eq_u32 s3, 11
    s_cselect_b32 s3, 0, s3
    s_waitcnt vmcnt(8)
    ds_read_b32 v1, v252 offset:40
    s_lshl_b32 s53, s68, 2
    s_add_u32 s53, s53, s64
    s_lshl_b32 s54, s53, 14
    s_lshl_b32 s55, s69, 7
    s_add_u32 s60, s54, s55
    s_add_u32 s61, s60, 8192
    v_lshrrev_b32 v12, 3, v0
    v_and_b32 v13, 7, v0
    v_lshlrev_b32 v14, 4, v13
    v_lshl_add_u32 v14, v12, 10, v14
    v_lshlrev_b32 v15, 4, v12
    buffer_load_dwordx4 v[176:179], v14, s[4:7], s60 offen
    buffer_load_dwordx4 v[180:183], v14, s[4:7], s61 offen
    s_waitcnt lgkmcnt(0)
    v_readfirstlane_b32 s70, v1
    s_branch L_bj
    .p2align 6
L_help:
    s_load_dwordx2 s[8:9], s[0:1], 56
    s_load_dwordx2 s[12:13], s[0:1], 64
    s_load_dwordx2 s[20:21], s[0:1], 8
    s_load_dwordx2 s[24:25], s[0:1], 16
    s_load_dwordx2 s[28:29], s[0:1], 24
    s_load_dwordx2 s[32:33], s[0:1], 72
    s_load_dwordx2 s[36:37], s[0:1], 80
    s_load_dwordx2 s[40:41], s[0:1], 32
    s_load_dwordx2 s[44:45], s[0:1], 40
    s_mov_b32 s6, 0x200000
    s_mov_b32 s7, 0x20000
    s_mov_b32 s10, 0x158000
    s_mov_b32 s11, 0x20000
    s_mov_b32 s14, 0x158000
    s_mov_b32 s15, 0x20000
    s_mov_b32 s18, 0x1500000
    s_mov_b32 s19, 0x20000
    s_mov_b32 s22, 0x200000
    s_mov_b32 s23, 0x20000
    s_mov_b32 s26, 0x200000
    s_mov_b32 s27, 0x20000
    s_mov_b32 s30, 0x1000
    s_mov_b32 s31, 0x20000
    s_mov_b32 s34, 0x158000
    s_mov_b32 s35, 0x20000
    s_mov_b32 s38, 0x200000
    s_mov_b32 s39, 0x20000
    s_mov_b32 s42, 0x200000
    s_mov_b32 s43, 0x20000
    s_and_b32 s53, s2, 1
    s_lshl_b32 s53, s53, 3
    s_bfe_u32 s54, s2, 0x30003
    s_add_u32 s49, s53, s54
    s_bfe_u32 s53, s2, 0x20001
    s_lshl_b32 s53, s53, 2
    s_lshr_b32 s55, s2, 6
    s_add_u32 s50, s53, s55
    s_mov_b32 s46, 0xd951c840
    s_mov_b32 s47, 0xea62fb73
    s_lshl_b32 s50, s50, 2
    s_lshr_b64 s[46:47], s[46:47], s50
    s_and_b32 s50, s46, 15
    s_mul_i32 s51, s50, 3
    s_lshr_b32 s53, s50, 2
    s_sub_u32 s51, s51, s53
    s_cmp_eq_u32 s50, 15
    s_subb_u32 s51, s51, 0
    s_bitcmp1_b32 0xc888, s50
    s_cselect_b32 s52, 2, 3
    s_and_b32 s64, s48, 3
    s_and_b32 s53, s48, 1
    s_lshl_b32 s53, s53, 2
    v_lshrrev_b32 v5, 4, v0
    v_add_u32 v5, s53, v5
    v_and_b32 v6, 7, v0
    v_xor_b32 v5, v5, v6
    v_lshlrev_b32 v5, 4, v5
    v_lshrrev_b32 v6, 3, v0
    v_lshl_add_u32 v14, v6, 10, v5
    v_lshrrev_b32 v5, 5, v0
    v_lshlrev_b32 v5, 1, v5
    v_and_b32 v6, 3, v0
    v_xor_b32 v5, v5, v6
    v_lshlrev_b32 v5, 4, v5
    v_lshrrev_b32 v6, 2, v0
    v_mul_u32_u24 v6, 2752, v6
    v_add_u32 v15, v6, v5
    s_lshl_b32 s67, s49, 4
    s_add_u32 s67, s67, s50
    s_and_b32 s53, s2, 1
    s_lshl_b32 s53, s53, 4
    s_and_b32 s54, s2, 6
    s_lshl_b32 s54, s54, 1
    s_add_u32 s53, s53, s54
    s_bfe_u32 s54, s2, 0x20003
    s_add_u32 s68, s53, s54
    s_lshr_b32 s69, s2, 5
    s_mov_b32 s75, 0
    s_mov_b32 s66, 0
    v_lshlrev_b32 v4, 4, v0
    v_mov_b32 v252, 138752
    v_mov_b32 v253, 1
    s_mov_b32 s76, 0xffff0000
    s_waitcnt lgkmcnt(0)
    s_barrier
    s_sub_u32 s65, s64, 2
    s_lshl_b32 s73, s67, 1
    s_add_u32 s73, s73, s65
    s_lshl_b32 s73, s73, 12
    s_lshr_b32 s53, s67, 3
    s_lshl_b32 s53, s53, 1
    s_add_u32 s53, s53, s65
    s_lshl_b32 s53, s53, 15
    s_and_b32 s54, s67, 7
    s_lshl_b32 s55, s54, 7
    s_add_u32 s74, s53, s55
    s_mul_i32 s59, s67, 5504
    s_mul_i32 s54, s65, 2816
    s_add_u32 s59, s59, s54
    v_mov_b32 v1, 0xae0000
    buffer_load_dword v1, v1, s[16:19], 0 offen sc1
    s_lshl_b32 s53, s67, 1
    s_add_u32 s53, s53, s65
    s_lshl_b32 s53, s53, 12
    v_bfe_u32 v5, v0, 2, 2
    v_lshlrev_b32 v5, 10, v5
    v_and_b32 v6, 3, v0
    v_lshl_add_u32 v5, v6, 4, v5
    v_lshrrev_b32 v6, 4, v0
    v_lshl_add_u32 v5, v6, 6, v5
    buffer_load_dwordx4 v[144:147], v5, s[4:7], s53 offen offset:0
    buffer_load_dwordx4 v[148:151], v5, s[4:7], s53 offen offset:256
    buffer_load_dwordx4 v[152:155], v5, s[4:7], s53 offen offset:512
    buffer_load_dwordx4 v[156:159], v5, s[4:7], s53 offen offset:768
    s_mul_i32 s53, s49, 88064
    s_lshl_b32 s54, s51, 6
    s_add_u32 s53, s53, s54
    s_add_u32 s54, s53, 44032
    s_mul_i32 s63, s65, 6144
    s_add_u32 s63, s63, 139264
    s_cmp_lg_u32 s65, 0
    s_cbranch_scc1 cs_35
    s_add_u32 m0, s63, 0
    s_nop 0
    buffer_load_dwordx4 v15, s[8:11], s53 offen offset:0  lds
    s_add_u32 m0, s63, 1024
    s_nop 0
    buffer_load_dwordx4 v15, s[8:11], s54 offen offset:0  lds
    s_add_u32 m0, s63, 1984
    s_nop 0
    buffer_load_dwordx4 v15, s[8:11], s53 offen offset:64  lds
    s_add_u32 m0, s63, 3008
    s_nop 0
    buffer_load_dwordx4 v15, s[8:11], s54 offen offset:64  lds
    s_add_u32 m0, s63, 3968
    s_nop 0
    buffer_load_dwordx4 v15, s[8:11], s53 offen offset:128  lds
    s_add_u32 m0, s63, 4992
    s_nop 0
    buffer_load_dwordx4 v15, s[8:11], s54 offen offset:128  lds
    s_branch cs_36
cs_35:
    s_add_u32 m0, s63, 0
    s_nop 0
    buffer_load_dwordx4 v15, s[12:15], s53 offen offset:0  lds
    s_add_u32 m0, s63, 1024
    s_nop 0
    buffer_load_dwordx4 v15, s[12:15], s54 offen offset:0  lds
    s_add_u32 m0, s63, 1984
    s_nop 0
    buffer_load_dwordx4 v15, s[12:15], s53 offen offset:64  lds
    s_add_u32 m0, s63, 3008
    s_nop 0
    buffer_load_dwordx4 v15, s[12:15], s54 offen offset:64  lds
    s_add_u32 m0, s63, 3968
    s_nop 0
    buffer_load_dwordx4 v15, s[12:15], s53 offen offset:128  lds
    s_add_u32 m0, s63, 4992
    s_nop 0
    buffer_load_dwordx4 v15, s[12:15], s54 offen offset:128  lds
cs_36:
    v_lshrrev_b32 v5, 3, v0
    v_lshlrev_b32 v5, 10, v5
    v_and_b32 v6, 7, v0
    v_lshl_add_u32 v5, v6, 4, v5
    v_add_u32 v69, s74, v5
    v_subrev_u32 v7, 0xc00, v69
    v_cmp_gt_u32 vcc, 0xc00, v69
    v_mov_b32 v68, 0x7ff00000
    s_nop 1
    v_cndmask_b32 v7, v7, v68, vcc
    s_mul_i32 s53, s65, 5120
    s_add_u32 s53, s53, 122880
    s_lshl_b32 s55, s65, 12
    s_add_u32 s55, s55, 155648
    s_add_u32 m0, s53, 0
    s_mov_b32 s54, 0
    buffer_load_dwordx4 v7, s[20:23], s54 offen nt lds
    s_add_u32 m0, s53, 1024
    s_mov_b32 s54, 5120
    buffer_load_dwordx4 v69, s[20:23], s54 offen nt lds
    s_add_u32 m0, s53, 2048
    s_mov_b32 s54, 13312
    buffer_load_dwordx4 v69, s[20:23], s54 offen nt lds
    s_add_u32 m0, s53, 3072
    s_mov_b32 s54, 21504
    buffer_load_dwordx4 v69, s[20:23], s54 offen nt lds
    s_add_u32 m0, s53, 4096
    s_mov_b32 s54, 29696
    buffer_load_dwordx4 v69, s[20:23], s54 offen nt lds
    s_add_u32 m0, s55, 0
    s_mov_b32 s54, 0
    buffer_load_dwordx4 v69, s[24:27], s54 offen nt lds
    s_add_u32 m0, s55, 1024
    s_mov_b32 s54, 8192
    buffer_load_dwordx4 v69, s[24:27], s54 offen nt lds
    s_add_u32 m0, s55, 2048
    s_mov_b32 s54, 16384
    buffer_load_dwordx4 v69, s[24:27], s54 offen nt lds
    s_add_u32 m0, s55, 3072
    s_mov_b32 s54, 24576
    buffer_load_dwordx4 v69, s[24:27], s54 offen nt lds
    v_and_b32 v6, 31, v0
    v_lshrrev_b32 v5, 5, v0
    v_lshlrev_b32 v5, 10, v5
    v_lshl_add_u32 v5, v6, 2, v5
    v_add_u32 v68, s53, v5
    v_add_u32 v69, s55, v5
    s_and_b32 s54, s67, 7
    s_lshl_b32 s54, s54, 9
    v_lshlrev_b32 v6, 4, v6
    buffer_load_dwordx4 v[64:67], v6, s[28:31], s54 offen
    v_lshlrev_b32 v11, 7, v0
    s_mov_b64 exec, 0x3fffff
    buffer_load_dword v71, v11, s[32:35], s59 offen
    s_mov_b64 exec, -1
    s_mul_i32 s71, s65, 22784
    s_add_u32 s71, s71, 81920
    buffer_load_dwordx4 v[202:205], v4, s[40:43], s73 offen offset:0 nt
    buffer_load_dwordx4 v[208:211], v4, s[40:43], s73 offen offset:1024 nt
    buffer_load_dwordx4 v[214:217], v4, s[40:43], s73 offen offset:2048 nt
    buffer_load_dwordx4 v[220:223], v4, s[40:43], s73 offen offset:3072 nt
    v_mov_b32 v192, 0x3f803f80
    v_mov_b32 v193, 0x3f803f80
    v_mov_b32 v194, 0x3f803f80
    v_mov_b32 v195, 0x3f803f80
    s_lshl_b32 s53, s49, 11
    v_and_b32 v9, 15, v0
    v_lshlrev_b32 v8, 7, v9
    v_add_u32 v8, s53, v8
    s_lshl_b32 s53, s50, 7
    v_lshlrev_b32 v9, 11, v9
    v_add_u32 v9, s53, v9
    v_cmp_lt_u32 vcc, 31, v0
    s_nop 1
    v_cndmask_b32 v8, v8, v9, vcc
    v_add_u32 v8, 0xa80000, v8
    s_waitcnt vmcnt(21)
    v_readfirstlane_b32 s70, v1
    s_nop 0
    s_add_u32 s70, s70, 0x9e3779b1
    v_mov_b32 v20, s70
    ds_write_b32 v252, v20 offset:40
    v_mfma_f32_16x16x32_bf16 v[72:75], v[144:147], v[144:147], 0
    v_mfma_f32_16x16x32_bf16 v[76:79], v[192:195], v[144:147], 0
    v_mfma_f32_16x16x32_bf16 v[72:75], v[148:151], v[148:151], v[72:75]
    v_mfma_f32_16x16x32_bf16 v[76:79], v[192:195], v[148:151], v[76:79]
    v_mfma_f32_16x16x32_bf16 v[72:75], v[152:155], v[152:155], v[72:75]
    v_mfma_f32_16x16x32_bf16 v[76:79], v[192:195], v[152:155], v[76:79]
    v_mfma_f32_16x16x32_bf16 v[72:75], v[156:159], v[156:159], v[72:75]
    v_mfma_f32_16x16x32_bf16 v[76:79], v[192:195], v[156:159], v[76:79]
    v_and_b32 v6, 3, v0
    v_cmp_eq_u32 vcc, 1, v6
    v_cmp_eq_u32 s[46:47], 2, v6
    v_cmp_eq_u32 s[60:61], 3, v6
    s_lshl_b32 s53, s67, 1
    s_add_u32 s53, s53, s65
    s_lshl_b32 s53, s53, 6
    s_add_u32 s53, s53, 0xa00000
    v_and_b32 v5, 48, v0
    s_nop 0
    v_cndmask_b32 v72, v72, v73, vcc
    v_cndmask_b32 v72, v72, v74, s[46:47]
    v_cndmask_b32 v72, v72, v75, s[60:61]
    s_nop 0
    v_add_f32_dpp v76, v76, v76 quad_perm:[1,0,3,2] row_mask:0xf bank_mask:0xf
    v_add_f32_dpp v72, v72, v72 quad_perm:[1,0,3,2] row_mask:0xf bank_mask:0xf
    s_nop 0
    v_add_f32_dpp v76, v76, v76 quad_perm:[2,3,0,1] row_mask:0xf bank_mask:0xf
    v_add_f32_dpp v72, v72, v72 quad_perm:[2,3,0,1] row_mask:0xf bank_mask:0xf
    v_mul_f32 v80, 0x3b000000, v76
    v_mul_f32 v82, 0x3b000000, v72
    v_fma_f32 v82, -v80, v80, v82
    v_max_f32 v82, 0, v82
    v_cvt_pk_bf16_f32 v80, v80, v80
    v_lshlrev_b32 v80, 16, v80
    v_cvt_pk_bf16_f32 v82, v82, v82
    v_lshlrev_b32 v82, 16, v82
    v_add_f32 v82, 0x3727c5ac, v82
    v_cvt_pk_bf16_f32 v82, v82, v82
    v_lshlrev_b32 v82, 16, v82
    v_sqrt_f32 v82, v82
    s_nop 0
    v_cvt_pk_bf16_f32 v82, v82, v82
    v_lshlrev_b32 v82, 16, v82
    v_rcp_f32 v81, v82
    v_mul_f32 v83, v82, v82
    v_mul_f32 v82, v81, v81
    v_mul_f32 v82, v82, v81
    v_mul_f32 v82, 0xbdd2d3e8, v82
    v_mul_f32 v81, 0xc0135761, v81
    s_mov_b32 s46, 0x00100001
    s_mov_b32 s47, 0x10000100
    s_mov_b64 exec, s[46:47]
    buffer_store_dwordx4 v[80:83], v5, s[16:19], s53 offen sc1
    s_mov_b64 exec, -1
    s_waitcnt vmcnt(16)
    v_lshrrev_b32 v5, 4, v0
    v_lshlrev_b32 v6, 9, v5
    v_bfe_u32 v7, v0, 2, 2
    v_lshl_add_u32 v6, v7, 6, v6
    v_and_b32 v7, 3, v0
    v_lshl_add_u32 v6, v7, 3, v6
    v_and_b32 v7, 1, v5
    v_lshl_add_u32 v6, v7, 5, v6
    v_add_u32 v6, s63, v6
    v_xor_b32 v7, 32, v6
    ds_read_b64_tr_b16 v[144:145], v6 offset:0
    ds_read_b64_tr_b16 v[146:147], v6 offset:256
    ds_read_b64_tr_b16 v[148:149], v7 offset:0
    ds_read_b64_tr_b16 v[150:151], v7 offset:256
    ds_read_b64_tr_b16 v[152:153], v6 offset:2048
    ds_read_b64_tr_b16 v[154:155], v6 offset:2304
    ds_read_b64_tr_b16 v[156:157], v7 offset:2048
    ds_read_b64_tr_b16 v[158:159], v7 offset:2304
    ds_read_b64_tr_b16 v[160:161], v6 offset:4096
    ds_read_b64_tr_b16 v[162:163], v6 offset:4352
    ds_read_b64_tr_b16 v[164:165], v7 offset:4096
    ds_read_b64_tr_b16 v[166:167], v7 offset:4352
    s_lshl_b32 s53, s50, 1
    s_add_u32 s53, s53, s65
    s_lshl_b32 s53, s53, 4
    s_add_u32 s53, s53, s49
    s_mul_i32 s53, s53, 384
    s_add_u32 s53, s53, 0xa10000
    v_and_b32 v5, 48, v0
    s_waitcnt lgkmcnt(0)
    v_mfma_f32_16x16x32_bf16 v[168:171], v[144:147], v[192:195], 0
    v_mfma_f32_16x16x32_bf16 v[172:175], v[148:151], v[192:195], 0
    v_mfma_f32_16x16x32_bf16 v[176:179], v[152:155], v[192:195], 0
    v_mfma_f32_16x16x32_bf16 v[180:183], v[156:159], v[192:195], 0
    v_mfma_f32_16x16x32_bf16 v[184:187], v[160:163], v[192:195], 0
    v_mfma_f32_16x16x32_bf16 v[188:191], v[164:167], v[192:195], 0
    s_mov_b32 s46, 0x00010001
    s_mov_b32 s47, 0x00010001
    s_nop 5
    s_mov_b64 exec, s[46:47]
    buffer_store_dwordx4 v[168:171], v5, s[16:19], s53 offen offset:0 sc1
    buffer_store_dwordx4 v[172:175], v5, s[16:19], s53 offen offset:64 sc1
    buffer_store_dwordx4 v[176:179], v5, s[16:19], s53 offen offset:128 sc1
    buffer_store_dwordx4 v[180:183], v5, s[16:19], s53 offen offset:192 sc1
    buffer_store_dwordx4 v[184:187], v5, s[16:19], s53 offen offset:256 sc1
    buffer_store_dwordx4 v[188:191], v5, s[16:19], s53 offen offset:320 sc1
    s_mov_b64 exec, -1
    s_waitcnt vmcnt(12)
    ds_read_b32 v24, v68 offset:0
    ds_read_b32 v25, v68 offset:128
    ds_read_b32 v26, v68 offset:256
    ds_read_b32 v27, v68 offset:384
    ds_read_b32 v28, v68 offset:512
    ds_read_b32 v29, v68 offset:640
    ds_read_b32 v30, v68 offset:768
    ds_read_b32 v31, v68 offset:896
    ds_read_b32 v32, v68 offset:1024
    ds_read_b32 v33, v68 offset:1152
    ds_read_b32 v34, v68 offset:1280
    ds_read_b32 v35, v69 offset:0
    ds_read_b32 v36, v69 offset:128
    ds_read_b32 v37, v69 offset:256
    ds_read_b32 v38, v69 offset:384
    ds_read_b32 v39, v69 offset:512
    ds_read_b32 v40, v69 offset:640
    ds_read_b32 v41, v69 offset:768
    ds_read_b32 v42, v69 offset:896
    ds_read_b32 v43, v68 offset:2048
    ds_read_b32 v44, v68 offset:2176
    ds_read_b32 v45, v68 offset:2304
    ds_read_b32 v46, v68 offset:2432
    ds_read_b32 v47, v68 offset:2560
    ds_read_b32 v48, v68 offset:2688
    ds_read_b32 v49, v68 offset:2816
    ds_read_b32 v50, v68 offset:2944
    ds_read_b32 v51, v68 offset:3072
    ds_read_b32 v52, v68 offset:3200
    ds_read_b32 v53, v68 offset:3328
    ds_read_b32 v54, v69 offset:2048
    ds_read_b32 v55, v69 offset:2176
    ds_read_b32 v56, v69 offset:2304
    ds_read_b32 v57, v69 offset:2432
    ds_read_b32 v58, v69 offset:2560
    ds_read_b32 v59, v69 offset:2688
    ds_read_b32 v60, v69 offset:2816
    ds_read_b32 v61, v69 offset:2944
    v_lshlrev_b32 v110, 16, v64
    v_lshlrev_b32 v111, 16, v66
    v_and_b32 v112, s76, v64
    v_and_b32 v113, s76, v66
    v_lshlrev_b32 v114, 16, v65
    v_lshlrev_b32 v115, 16, v67
    v_and_b32 v116, s76, v65
    v_and_b32 v117, s76, v67
    v_and_b32 v70, 31, v0
    v_mul_u32_u24 v70, 160, v70
    v_lshrrev_b32 v5, 5, v0
    v_lshlrev_b32 v5, 4, v5
    v_sub_u32 v70, v70, v5
    s_mul_i32 s53, s65, 5120
    s_add_u32 s53, s53, 122896
    v_add_u32 v70, s53, v70
    s_waitcnt lgkmcnt(0)
    v_lshlrev_b32 v72, 16, v24
    v_and_b32 v73, s76, v24
    v_lshlrev_b32 v74, 16, v25
    v_and_b32 v75, s76, v25
    v_lshlrev_b32 v76, 16, v26
    v_and_b32 v77, s76, v26
    v_lshlrev_b32 v78, 16, v27
    v_and_b32 v79, s76, v27
    v_lshlrev_b32 v80, 16, v28
    v_and_b32 v81, s76, v28
    v_lshlrev_b32 v82, 16, v29
    v_and_b32 v83, s76, v29
    v_lshlrev_b32 v84, 16, v30
    v_and_b32 v85, s76, v30
    v_lshlrev_b32 v86, 16, v31
    v_and_b32 v87, s76, v31
    v_lshlrev_b32 v88, 16, v32
    v_and_b32 v89, s76, v32
    v_lshlrev_b32 v90, 16, v33
    v_and_b32 v91, s76, v33
    v_lshlrev_b32 v92, 16, v34
    v_and_b32 v93, s76, v34
    v_mul_f32 v128, v72, v116
    v_mul_f32 v129, v73, v117
    v_mul_f32 v130, v74, v116
    v_mul_f32 v131, v75, v117
    v_mul_f32 v132, v76, v116
    v_mul_f32 v133, v77, v117
    v_mul_f32 v134, v78, v116
    v_mul_f32 v135, v79, v117
    v_mul_f32 v136, v80, v116
    v_mul_f32 v137, v81, v117
    v_mul_f32 v138, v82, v116
    v_mul_f32 v139, v83, v117
    v_mul_f32 v140, v84, v116
    v_mul_f32 v141, v85, v117
    v_mul_f32 v142, v86, v116
    v_mul_f32 v143, v87, v117
    v_fmac_f32 v128, v74, v114
    v_fmac_f32 v129, v75, v115
    v_fmac_f32 v130, v76, v114
    v_fmac_f32 v131, v77, v115
    v_fmac_f32 v132, v78, v114
    v_fmac_f32 v133, v79, v115
    v_fmac_f32 v134, v80, v114
    v_fmac_f32 v135, v81, v115
    v_fmac_f32 v136, v82, v114
    v_fmac_f32 v137, v83, v115
    v_fmac_f32 v138, v84, v114
    v_fmac_f32 v139, v85, v115
    v_fmac_f32 v140, v86, v114
    v_fmac_f32 v141, v87, v115
    v_fmac_f32 v142, v88, v114
    v_fmac_f32 v143, v89, v115
    v_fmac_f32 v128, v76, v112
    v_fmac_f32 v129, v77, v113
    v_fmac_f32 v130, v78, v112
    v_fmac_f32 v131, v79, v113
    v_fmac_f32 v132, v80, v112
    v_fmac_f32 v133, v81, v113
    v_fmac_f32 v134, v82, v112
    v_fmac_f32 v135, v83, v113
    v_fmac_f32 v136, v84, v112
    v_fmac_f32 v137, v85, v113
    v_fmac_f32 v138, v86, v112
    v_fmac_f32 v139, v87, v113
    v_fmac_f32 v140, v88, v112
    v_fmac_f32 v141, v89, v113
    v_fmac_f32 v142, v90, v112
    v_fmac_f32 v143, v91, v113
    v_fmac_f32 v128, v78, v110
    v_fmac_f32 v129, v79, v111
    v_fmac_f32 v130, v80, v110
    v_fmac_f32 v131, v81, v111
    v_fmac_f32 v132, v82, v110
    v_fmac_f32 v133, v83, v111
    v_fmac_f32 v134, v84, v110
    v_fmac_f32 v135, v85, v111
    v_fmac_f32 v136, v86, v110
    v_fmac_f32 v137, v87, v111
    v_fmac_f32 v138, v88, v110
    v_fmac_f32 v139, v89, v111
    v_fmac_f32 v140, v90, v110
    v_fmac_f32 v141, v91, v111
    v_fmac_f32 v142, v92, v110
    v_fmac_f32 v143, v93, v111
    v_lshlrev_b32 v94, 16, v35
    v_and_b32 v95, s76, v35
    v_lshlrev_b32 v96, 16, v36
    v_and_b32 v97, s76, v36
    v_lshlrev_b32 v98, 16, v37
    v_and_b32 v99, s76, v37
    v_lshlrev_b32 v100, 16, v38
    v_and_b32 v101, s76, v38
    v_lshlrev_b32 v102, 16, v39
    v_and_b32 v103, s76, v39
    v_lshlrev_b32 v104, 16, v40
    v_and_b32 v105, s76, v40
    v_lshlrev_b32 v106, 16, v41
    v_and_b32 v107, s76, v41
    v_lshlrev_b32 v108, 16, v42
    v_and_b32 v109, s76, v42
    v_mul_f32 v128, v128, v94
    v_mul_f32 v129, v129, v95
    v_mul_f32 v130, v130, v96
    v_mul_f32 v131, v131, v97
    v_mul_f32 v132, v132, v98
    v_mul_f32 v133, v133, v99
    v_mul_f32 v134, v134, v100
    v_mul_f32 v135, v135, v101
    v_mul_f32 v136, v136, v102
    v_mul_f32 v137, v137, v103
    v_mul_f32 v138, v138, v104
    v_mul_f32 v139, v139, v105
    v_mul_f32 v140, v140, v106
    v_mul_f32 v141, v141, v107
    v_mul_f32 v142, v142, v108
    v_mul_f32 v143, v143, v109
    v_cvt_pk_bf16_f32 v120, v142, v140
    v_cvt_pk_bf16_f32 v121, v138, v136
    v_cvt_pk_bf16_f32 v122, v134, v132
    v_cvt_pk_bf16_f32 v123, v130, v128
    v_cvt_pk_bf16_f32 v124, v143, v141
    v_cvt_pk_bf16_f32 v125, v139, v137
    v_cvt_pk_bf16_f32 v126, v135, v133
    v_cvt_pk_bf16_f32 v127, v131, v129
    ds_write_b128 v70, v[120:123] offset:32
    ds_write_b128 v70, v[124:127] offset:112
    s_waitcnt vmcnt(0)
    s_lshl_b32 s53, s67, 7
    s_lshl_b32 s54, s65, 2
    s_add_u32 s53, s53, s54
    s_add_u32 s53, s53, 0xa80000
    v_mov_b32 v196, s70
    v_mov_b32 v197, 0
    s_mov_b64 exec, 1
    buffer_store_dword v196, v197, s[16:19], s53 offen sc1
    s_mov_b64 exec, -1
    v_lshlrev_b32 v72, 16, v43
    v_and_b32 v73, s76, v43
    v_lshlrev_b32 v74, 16, v44
    v_and_b32 v75, s76, v44
    v_lshlrev_b32 v76, 16, v45
    v_and_b32 v77, s76, v45
    v_lshlrev_b32 v78, 16, v46
    v_and_b32 v79, s76, v46
    v_lshlrev_b32 v80, 16, v47
    v_and_b32 v81, s76, v47
    v_lshlrev_b32 v82, 16, v48
    v_and_b32 v83, s76, v48
    v_lshlrev_b32 v84, 16, v49
    v_and_b32 v85, s76, v49
    v_lshlrev_b32 v86, 16, v50
    v_and_b32 v87, s76, v50
    v_lshlrev_b32 v88, 16, v51
    v_and_b32 v89, s76, v51
    v_lshlrev_b32 v90, 16, v52
    v_and_b32 v91, s76, v52
    v_lshlrev_b32 v92, 16, v53
    v_and_b32 v93, s76, v53
    v_mul_f32 v128, v72, v116
    v_mul_f32 v129, v73, v117
    v_mul_f32 v130, v74, v116
    v_mul_f32 v131, v75, v117
    v_mul_f32 v132, v76, v116
    v_mul_f32 v133, v77, v117
    v_mul_f32 v134, v78, v116
    v_mul_f32 v135, v79, v117
    v_mul_f32 v136, v80, v116
    v_mul_f32 v137, v81, v117
    v_mul_f32 v138, v82, v116
    v_mul_f32 v139, v83, v117
    v_mul_f32 v140, v84, v116
    v_mul_f32 v141, v85, v117
    v_mul_f32 v142, v86, v116
    v_mul_f32 v143, v87, v117
    v_fmac_f32 v128, v74, v114
    v_fmac_f32 v129, v75, v115
    v_fmac_f32 v130, v76, v114
    v_fmac_f32 v131, v77, v115
    v_fmac_f32 v132, v78, v114
    v_fmac_f32 v133, v79, v115
    v_fmac_f32 v134, v80, v114
    v_fmac_f32 v135, v81, v115
    v_fmac_f32 v136, v82, v114
    v_fmac_f32 v137, v83, v115
    v_fmac_f32 v138, v84, v114
    v_fmac_f32 v139, v85, v115
    v_fmac_f32 v140, v86, v114
    v_fmac_f32 v141, v87, v115
    v_fmac_f32 v142, v88, v114
    v_fmac_f32 v143, v89, v115
    v_fmac_f32 v128, v76, v112
    v_fmac_f32 v129, v77, v113
    v_fmac_f32 v130, v78, v112
    v_fmac_f32 v131, v79, v113
    v_fmac_f32 v132, v80, v112
    v_fmac_f32 v133, v81, v113
    v_fmac_f32 v134, v82, v112
    v_fmac_f32 v135, v83, v113
    v_fmac_f32 v136, v84, v112
    v_fmac_f32 v137, v85, v113
    v_fmac_f32 v138, v86, v112
    v_fmac_f32 v139, v87, v113
    v_fmac_f32 v140, v88, v112
    v_fmac_f32 v141, v89, v113
    v_fmac_f32 v142, v90, v112
    v_fmac_f32 v143, v91, v113
    v_fmac_f32 v128, v78, v110
    v_fmac_f32 v129, v79, v111
    v_fmac_f32 v130, v80, v110
    v_fmac_f32 v131, v81, v111
    v_fmac_f32 v132, v82, v110
    v_fmac_f32 v133, v83, v111
    v_fmac_f32 v134, v84, v110
    v_fmac_f32 v135, v85, v111
    v_fmac_f32 v136, v86, v110
    v_fmac_f32 v137, v87, v111
    v_fmac_f32 v138, v88, v110
    v_fmac_f32 v139, v89, v111
    v_fmac_f32 v140, v90, v110
    v_fmac_f32 v141, v91, v111
    v_fmac_f32 v142, v92, v110
    v_fmac_f32 v143, v93, v111
    v_lshlrev_b32 v94, 16, v54
    v_and_b32 v95, s76, v54
    v_lshlrev_b32 v96, 16, v55
    v_and_b32 v97, s76, v55
    v_lshlrev_b32 v98, 16, v56
    v_and_b32 v99, s76, v56
    v_lshlrev_b32 v100, 16, v57
    v_and_b32 v101, s76, v57
    v_lshlrev_b32 v102, 16, v58
    v_and_b32 v103, s76, v58
    v_lshlrev_b32 v104, 16, v59
    v_and_b32 v105, s76, v59
    v_lshlrev_b32 v106, 16, v60
    v_and_b32 v107, s76, v60
    v_lshlrev_b32 v108, 16, v61
    v_and_b32 v109, s76, v61
    v_mul_f32 v128, v128, v94
    v_mul_f32 v129, v129, v95
    v_mul_f32 v130, v130, v96
    v_mul_f32 v131, v131, v97
    v_mul_f32 v132, v132, v98
    v_mul_f32 v133, v133, v99
    v_mul_f32 v134, v134, v100
    v_mul_f32 v135, v135, v101
    v_mul_f32 v136, v136, v102
    v_mul_f32 v137, v137, v103
    v_mul_f32 v138, v138, v104
    v_mul_f32 v139, v139, v105
    v_mul_f32 v140, v140, v106
    v_mul_f32 v141, v141, v107
    v_mul_f32 v142, v142, v108
    v_mul_f32 v143, v143, v109
    v_cvt_pk_bf16_f32 v120, v142, v140
    v_cvt_pk_bf16_f32 v121, v138, v136
    v_cvt_pk_bf16_f32 v122, v134, v132
    v_cvt_pk_bf16_f32 v123, v130, v128
    v_cvt_pk_bf16_f32 v124, v143, v141
    v_cvt_pk_bf16_f32 v125, v139, v137
    v_cvt_pk_bf16_f32 v126, v135, v133
    v_cvt_pk_bf16_f32 v127, v131, v129
    ds_write_b128 v70, v[120:123] offset:0
    ds_write_b128 v70, v[124:127] offset:80
    v_lshrrev_b32 v5, 2, v0
    v_and_b32 v6, 3, v0
    v_lshlrev_b32 v6, 4, v6
    v_mul_u32_u24 v7, 80, v5
    v_add_u32 v7, v7, v6
    s_mul_i32 s53, s65, 5120
    s_add_u32 s53, s53, 122880
    v_add_u32 v7, s53, v7
    s_waitcnt lgkmcnt(0)
    ds_read_b128 v[24:27], v7 offset:0
    ds_read_b128 v[28:31], v7 offset:1280
    ds_read_b128 v[32:35], v7 offset:2560
    ds_read_b128 v[36:39], v7 offset:3840
    v_lshl_add_u32 v5, v5, 12, v6
    s_and_b32 s53, s67, 7
    s_lshl_b32 s53, s53, 18
    s_lshr_b32 s54, s67, 3
    s_lshl_b32 s54, s54, 1
    s_add_u32 s54, s54, s65
    s_lshl_b32 s54, s54, 6
    s_sub_u32 s53, s53, s54
    s_add_u32 s53, s53, 0x600fc0
    s_waitcnt lgkmcnt(3)
    buffer_store_dwordx4 v[24:27], v5, s[16:19], s53 offen sc1
    s_add_u32 s53, s53, 65536
    s_waitcnt lgkmcnt(2)
    buffer_store_dwordx4 v[28:31], v5, s[16:19], s53 offen sc1
    s_add_u32 s53, s53, 65536
    s_waitcnt lgkmcnt(1)
    buffer_store_dwordx4 v[32:35], v5, s[16:19], s53 offen sc1
    s_add_u32 s53, s53, 65536
    s_waitcnt lgkmcnt(0)
    buffer_store_dwordx4 v[36:39], v5, s[16:19], s53 offen sc1
    s_add_u32 s53, s53, 65536
    s_mov_b64 exec, 1
    ds_add_u32 v252, v253 offset:12
    s_mov_b64 exec, -1
    s_waitcnt vmcnt(0)
    s_lshl_b32 s53, s67, 7
    s_lshl_b32 s54, s65, 2
    s_add_u32 s53, s53, s54
    s_add_u32 s53, s53, 0xa88000
    v_mov_b32 v196, s70
    v_mov_b32 v197, 0
    s_mov_b64 exec, 1
    buffer_store_dword v196, v197, s[16:19], s53 offen sc1
    s_mov_b64 exec, -1
    v_mov_b32 v24, 0
    v_mov_b32 v25, 0
    v_mov_b32 v26, 0
    v_mov_b32 v27, 0
    v_add_u32 v10, s71, v4
    v_mov_b32 v200, 0
    v_mov_b32 v201, 0
    v_mov_b32_dpp v206, v204 wave_ror:1 row_mask:0xf bank_mask:0xf
    v_mov_b32_dpp v207, v205 wave_ror:1 row_mask:0xf bank_mask:0xf
    v_mov_b32_dpp v212, v210 wave_ror:1 row_mask:0xf bank_mask:0xf
    v_mov_b32_dpp v213, v211 wave_ror:1 row_mask:0xf bank_mask:0xf
    v_mov_b32_dpp v218, v216 wave_ror:1 row_mask:0xf bank_mask:0xf
    v_mov_b32_dpp v219, v217 wave_ror:1 row_mask:0xf bank_mask:0xf
    v_mov_b32_dpp v200, v204 wave_shr:1 row_mask:0xf bank_mask:0xf
    v_mov_b32_dpp v201, v205 wave_shr:1 row_mask:0xf bank_mask:0xf
    v_mov_b32_dpp v206, v210 wave_shr:1 row_mask:0xf bank_mask:0xf
    v_mov_b32_dpp v207, v211 wave_shr:1 row_mask:0xf bank_mask:0xf
    v_mov_b32_dpp v212, v216 wave_shr:1 row_mask:0xf bank_mask:0xf
    v_mov_b32_dpp v213, v217 wave_shr:1 row_mask:0xf bank_mask:0xf
    v_mov_b32_dpp v218, v222 wave_shr:1 row_mask:0xf bank_mask:0xf
    v_mov_b32_dpp v219, v223 wave_shr:1 row_mask:0xf bank_mask:0xf
    v_alignbit_b32 v72, v202, v201, 16
    v_alignbit_b32 v73, v203, v202, 16
    v_alignbit_b32 v74, v204, v203, 16
    v_alignbit_b32 v75, v205, v204, 16
    v_mov_b32 v76, v201
    v_mov_b32 v77, v202
    v_mov_b32 v78, v203
    v_mov_b32 v79, v204
    v_alignbit_b32 v80, v201, v200, 16
    v_alignbit_b32 v81, v202, v201, 16
    v_alignbit_b32 v82, v203, v202, 16
    v_alignbit_b32 v83, v204, v203, 16
    v_alignbit_b32 v84, v208, v207, 16
    v_alignbit_b32 v85, v209, v208, 16
    v_alignbit_b32 v86, v210, v209, 16
    v_alignbit_b32 v87, v211, v210, 16
    v_mov_b32 v88, v207
    v_mov_b32 v89, v208
    v_mov_b32 v90, v209
    v_mov_b32 v91, v210
    v_alignbit_b32 v92, v207, v206, 16
    v_alignbit_b32 v93, v208, v207, 16
    v_alignbit_b32 v94, v209, v208, 16
    v_alignbit_b32 v95, v210, v209, 16
    v_alignbit_b32 v96, v214, v213, 16
    v_alignbit_b32 v97, v215, v214, 16
    v_alignbit_b32 v98, v216, v215, 16
    v_alignbit_b32 v99, v217, v216, 16
    v_mov_b32 v100, v213
    v_mov_b32 v101, v214
    v_mov_b32 v102, v215
    v_mov_b32 v103, v216
    v_alignbit_b32 v104, v213, v212, 16
    v_alignbit_b32 v105, v214, v213, 16
    v_alignbit_b32 v106, v215, v214, 16
    v_alignbit_b32 v107, v216, v215, 16
    v_alignbit_b32 v108, v220, v219, 16
    v_alignbit_b32 v109, v221, v220, 16
    v_alignbit_b32 v110, v222, v221, 16
    v_alignbit_b32 v111, v223, v222, 16
    v_mov_b32 v112, v219
    v_mov_b32 v113, v220
    v_mov_b32 v114, v221
    v_mov_b32 v115, v222
    v_alignbit_b32 v116, v219, v218, 16
    v_alignbit_b32 v117, v220, v219, 16
    v_alignbit_b32 v118, v221, v220, 16
    v_alignbit_b32 v119, v222, v221, 16
lw_37:
    ds_read_b32 v20, v252 offset:64
    s_waitcnt lgkmcnt(0)
    s_nop 0
    v_readfirstlane_b32 s53, v20
    s_nop 0
    s_cmp_ge_u32 s53, 7
    s_cbranch_scc1 lw_ok_38
    s_sleep 1
    s_add_u32 s75, s75, 1
    s_cmp_lt_u32 s75, 4194304
    s_cbranch_scc1 lw_37
lw_ok_38:
    buffer_load_dwordx2 v[198:199], v8, s[16:19], 0 offen sc1
    s_lshr_b32 s53, s67, 5
    s_lshl_b32 s53, s53, 7
    s_add_u32 s53, s53, 0xa88000
    v_and_b32 v16, 31, v0
    v_lshlrev_b32 v16, 10, v16
    v_add_u32 v16, s53, v16
    s_waitcnt vmcnt(0)
    s_mov_b32 s75, 0
poll_39:
    v_cmp_ne_u32 vcc, s70, v198
    v_cmp_ne_u32 s[46:47], s70, v199
    s_nop 0
    s_or_b64 vcc, vcc, s[46:47]
    s_cbranch_scc0 poll_ok_40
    s_add_u32 s75, s75, 1
    s_cmp_ge_u32 s75, 65536
    s_cbranch_scc1 poll_ok_40
    s_sleep 1
    buffer_load_dwordx2 v[198:199], v8, s[16:19], 0 offen sc1
    s_waitcnt vmcnt(0)
    s_branch poll_39
poll_ok_40:
lw_41:
    ds_read_b32 v20, v252 offset:64
    s_waitcnt lgkmcnt(0)
    s_nop 0
    v_readfirstlane_b32 s53, v20
    s_nop 0
    s_cmp_ge_u32 s53, 7
    s_cbranch_scc1 lw_ok_42
    s_sleep 1
    s_add_u32 s75, s75, 1
    s_cmp_lt_u32 s75, 4194304
    s_cbranch_scc1 lw_41
lw_ok_42:
    buffer_load_dwordx2 v[18:19], v16, s[16:19], 0 offen sc1
    s_lshl_b32 s53, s49, 1
    s_add_u32 s53, s53, s65
    s_lshl_b32 s53, s53, 10
    s_add_u32 s53, s53, 0xa00000
    buffer_load_dwordx4 v[224:227], v4, s[16:19], s53 offen sc1
    s_lshl_b32 s53, s50, 1
    s_add_u32 s53, s53, s65
    s_mul_i32 s53, s53, 6144
    s_add_u32 s53, s53, 0xa10000
    v_and_b32 v5, 31, v0
    v_lshlrev_b32 v5, 4, v5
    v_lshrrev_b32 v6, 5, v0
    v_mul_u32_u24 v6, 3072, v6
    v_add_u32 v6, v5, v6
    buffer_load_dwordx4 v[144:147], v6, s[16:19], s53 offen offset:0 sc1
    buffer_load_dwordx4 v[148:151], v6, s[16:19], s53 offen offset:384 sc1
    buffer_load_dwordx4 v[152:155], v6, s[16:19], s53 offen offset:768 sc1
    buffer_load_dwordx4 v[156:159], v6, s[16:19], s53 offen offset:1152 sc1
    buffer_load_dwordx4 v[160:163], v6, s[16:19], s53 offen offset:1536 sc1
    buffer_load_dwordx4 v[164:167], v6, s[16:19], s53 offen offset:1920 sc1
    buffer_load_dwordx4 v[168:171], v6, s[16:19], s53 offen offset:2304 sc1
    buffer_load_dwordx4 v[172:175], v6, s[16:19], s53 offen offset:2688 sc1
    s_lshl_b32 s53, s65, 10
    s_add_u32 s53, s53, 136704
    v_add_u32 v9, s53, v4
    s_waitcnt vmcnt(9)
    v_cmp_ne_u32 vcc, s70, v18
    v_cmp_ne_u32 s[46:47], s70, v19
    s_nop 0
    s_or_b64 vcc, vcc, s[46:47]
    s_cbranch_scc1 u_late_43
    s_add_u32 s55, s73, 0x600000
    buffer_load_dwordx4 v[128:131], v4, s[16:19], s55 offen offset:0 sc1
    buffer_load_dwordx4 v[132:135], v4, s[16:19], s55 offen offset:1024 sc1
    buffer_load_dwordx4 v[136:139], v4, s[16:19], s55 offen offset:2048 sc1
    buffer_load_dwordx4 v[140:143], v4, s[16:19], s55 offen offset:3072 sc1
    s_waitcnt vmcnt(4)
    ds_write_b128 v9, v[224:227]
    v_add_f32 v144, v144, v160
    v_add_f32 v145, v145, v161
    v_add_f32 v146, v146, v162
    v_add_f32 v147, v147, v163
    v_add_f32 v148, v148, v164
    v_add_f32 v149, v149, v165
    v_add_f32 v150, v150, v166
    v_add_f32 v151, v151, v167
    v_add_f32 v152, v152, v168
    v_add_f32 v153, v153, v169
    v_add_f32 v154, v154, v170
    v_add_f32 v155, v155, v171
    v_add_f32 v156, v156, v172
    v_add_f32 v157, v157, v173
    v_add_f32 v158, v158, v174
    v_add_f32 v159, v159, v175
    v_add_f32 v144, v144, v152
    v_add_f32 v145, v145, v153
    v_add_f32 v146, v146, v154
    v_add_f32 v147, v147, v155
    v_add_f32 v148, v148, v156
    v_add_f32 v149, v149, v157
    v_add_f32 v150, v150, v158
    v_add_f32 v151, v151, v159
    v_add_f32 v144, v144, v148
    v_add_f32 v145, v145, v149
    v_add_f32 v146, v146, v150
    v_add_f32 v147, v147, v151
    v_mov_b32 v148, v144
    v_mov_b32 v149, v145
    v_mov_b32 v150, v146
    v_mov_b32 v151, v147
    s_lshl_b32 s53, s65, 9
    s_add_u32 s53, s53, 135680
    v_and_b32 v8, 31, v0
    v_lshlrev_b32 v8, 4, v8
    v_add_u32 v8, s53, v8
    v_permlane32_swap_b32 v144, v148
    v_permlane32_swap_b32 v145, v149
    v_permlane32_swap_b32 v146, v150
    v_permlane32_swap_b32 v147, v151
    s_nop 0
    v_add_f32 v144, v144, v148
    v_add_f32 v145, v145, v149
    v_add_f32 v146, v146, v150
    v_add_f32 v147, v147, v151
    ds_write_b128 v8, v[144:147]
    s_mov_b64 exec, 1
    ds_add_u32 v252, v253 offset:8
    s_mov_b64 exec, -1
u_join_44:
    s_lshl_b32 s53, s68, 2
    s_add_u32 s53, s53, s64
    s_lshl_b32 s54, s53, 14
    s_lshl_b32 s55, s69, 7
    s_add_u32 s60, s54, s55
    s_add_u32 s61, s60, 8192
    v_lshrrev_b32 v12, 3, v0
    v_and_b32 v13, 7, v0
    v_lshlrev_b32 v14, 4, v13
    v_lshl_add_u32 v14, v12, 10, v14
    v_lshlrev_b32 v15, 4, v12
    buffer_load_dwordx4 v[176:179], v14, s[4:7], s60 offen
    buffer_load_dwordx4 v[180:183], v14, s[4:7], s61 offen
lw_47:
    ds_read_b128 v[20:23], v252 offset:16
    s_waitcnt lgkmcnt(0)
    v_min3_u32 v20, v20, v21, v22
    v_min_u32 v20, v20, v23
    s_nop 0
    v_readfirstlane_b32 s53, v20
    s_nop 0
    s_cmp_ge_u32 s53, 6
    s_cbranch_scc1 lw_ok_48
    s_sleep 1
    s_add_u32 s75, s75, 1
    s_cmp_lt_u32 s75, 4194304
    s_cbranch_scc1 lw_47
lw_ok_48:
lw_49:
    ds_read_b32 v20, v252 offset:12
    s_waitcnt lgkmcnt(0)
    s_nop 0
    v_readfirstlane_b32 s53, v20
    s_nop 0
    s_cmp_ge_u32 s53, 2
    s_cbranch_scc1 lw_ok_50
    s_sleep 1
    s_add_u32 s75, s75, 1
    s_cmp_lt_u32 s75, 4194304
    s_cbranch_scc1 lw_49
lw_ok_50:
    s_mov_b64 exec, 0xffffff
    ds_write_b128 v10, v[24:27] offset:0
    ds_write_b128 v10, v[24:27] offset:4640
    ds_write_b128 v10, v[24:27] offset:9280
    ds_write_b128 v10, v[24:27] offset:13920
    s_mov_b64 exec, 0xff
    ds_write_b128 v10, v[24:27] offset:22656
    s_mov_b64 exec, -1
    ds_write_b128 v10, v[202:205] offset:384
    ds_write_b128 v10, v[72:75] offset:5024
    ds_write_b128 v10, v[76:79] offset:9664
    ds_write_b128 v10, v[80:83] offset:14304
    ds_write_b128 v10, v[208:211] offset:1408
    ds_write_b128 v10, v[84:87] offset:6048
    ds_write_b128 v10, v[88:91] offset:10688
    ds_write_b128 v10, v[92:95] offset:15328
    ds_write_b128 v10, v[214:217] offset:2432
    ds_write_b128 v10, v[96:99] offset:7072
    ds_write_b128 v10, v[100:103] offset:11712
    ds_write_b128 v10, v[104:107] offset:16352
    ds_write_b128 v10, v[220:223] offset:3456
    ds_write_b128 v10, v[108:111] offset:8096
    ds_write_b128 v10, v[112:115] offset:12736
    ds_write_b128 v10, v[116:119] offset:17376
    s_waitcnt vmcnt(2)
    ds_write_b128 v10, v[128:131] offset:18560
    ds_write_b128 v10, v[132:135] offset:19584
    ds_write_b128 v10, v[136:139] offset:20608
    ds_write_b128 v10, v[140:143] offset:21632
L_bj:
    s_lshr_b32 s53, s64, 1
    s_mul_i32 s71, s53, 22784
    s_add_u32 s71, s71, 81920
    s_lshl_b32 s56, s67, 2
    s_load_dword s77, s[44:45], s56
    s_and_b32 s53, s64, 1
    s_lshl_b32 s53, s53, 8
    s_add_u32 s53, s53, s71
    v_and_b32 v6, 3, v0
    v_sub_u32 v6, 3, v6
    v_mul_u32_u24 v6, 4640, v6
    v_bfe_u32 v7, v0, 2, 2
    v_lshl_add_u32 v6, v7, 7, v6
    v_and_b32 v7, 48, v0
    v_add3_u32 v2, v6, v7, s53
    v_and_b32 v6, 15, v0
    v_lshlrev_b32 v6, 3, v6
    v_sub_u32 v6, v7, v6
    s_add_u32 s53, s53, 18680
    v_add_u32 v3, s53, v6
    s_lshl_b32 s53, s64, 13
    s_add_u32 s53, s53, 81920
    v_add_u32 v8, s53, v4
    s_lshl_b32 s53, s64, 11
    s_add_u32 s53, s53, 81920
    v_lshlrev_b32 v9, 3, v0
    v_add_u32 v9, s53, v9
    s_lshl_b32 s53, s64, 10
    s_sub_u32 s53, 103804, s53
    v_lshlrev_b32 v10, 2, v0
    v_sub_u32 v10, s53, v10
    s_mul_i32 s53, s67, 16640
    s_lshl_b32 s54, s64, 12
    s_add_u32 s53, s53, s54
    s_add_u32 s73, s53, 0x1000000
    s_lshl_b32 s53, s64, 8
    s_add_u32 s53, s53, s67
    s_lshl_b32 s53, s53, 7
    s_add_u32 s74, s53, 0xac0000
    s_mov_b32 s72, 0
    s_lshl_b32 s53, s64, 2
    v_add_u32 v11, s53, v252
    v_mov_b32 v251, 3
    s_lshl_b32 s54, s68, 2
    s_add_u32 s54, s54, s64
    s_lshl_b32 s54, s54, 8
    s_add_u32 s54, s54, 0xa80000
    v_and_b32 v5, 1, v0
    v_lshlrev_b32 v5, 7, v5
    v_add_u32 v5, s54, v5
    buffer_load_dwordx2 v[198:199], v5, s[16:19], 0 offen sc1
    s_add_u32 s72, s72, 8
    s_mov_b64 exec, 1
    ds_add_u32 v252, v253
    s_mov_b64 exec, -1
lw_51:
    ds_read_b32 v6, v252 offset:0
    s_waitcnt lgkmcnt(0)
    s_nop 0
    v_readfirstlane_b32 s53, v6
    s_nop 0
    s_cmp_ge_u32 s53, s72
    s_cbranch_scc1 lw_ok_52
    s_add_u32 s75, s75, 1
    s_cmp_lt_u32 s75, 4194304
    s_cbranch_scc1 lw_51
lw_ok_52:
    s_setprio 3
    ds_read_b128 v[48:51], v2 offset:0
    ds_read_b64 v[80:81], v3 offset:3584
    ds_read_b64 v[82:83], v3 offset:3592
    ds_read_b128 v[52:55], v2 offset:512
    ds_read_b64 v[84:85], v3 offset:3072
    ds_read_b64 v[86:87], v3 offset:3080
    ds_read_b128 v[56:59], v2 offset:1024
    ds_read_b64 v[88:89], v3 offset:2560
    ds_read_b64 v[90:91], v3 offset:2568
    ds_read_b128 v[60:63], v2 offset:1536
    ds_read_b64 v[92:93], v3 offset:2048
    ds_read_b64 v[94:95], v3 offset:2056
    ds_read_b128 v[64:67], v2 offset:2048
    ds_read_b64 v[96:97], v3 offset:1536
    ds_read_b64 v[98:99], v3 offset:1544
    ds_read_b128 v[68:71], v2 offset:2560
    ds_read_b64 v[100:101], v3 offset:1024
    ds_read_b64 v[102:103], v3 offset:1032
    ds_read_b128 v[72:75], v2 offset:3072
    ds_read_b64 v[104:105], v3 offset:512
    ds_read_b64 v[106:107], v3 offset:520
    ds_read_b128 v[76:79], v2 offset:3584
    ds_read_b64 v[108:109], v3 offset:0
    ds_read_b64 v[110:111], v3 offset:8
    s_waitcnt lgkmcnt(0)
    ds_read_b128 v[112:115], v2 offset:64
    v_mfma_f32_16x16x32_bf16 v[16:19], v[48:51], v[80:83], 0
    ds_read_b64 v[144:145], v3 offset:3648
    v_mfma_f32_16x16x32_bf16 v[20:23], v[48:51], v[84:87], 0
    ds_read_b64 v[146:147], v3 offset:3656
    v_mfma_f32_16x16x32_bf16 v[20:23], v[52:55], v[80:83], v[20:23]
    ds_read_b128 v[116:119], v2 offset:576
    v_mfma_f32_16x16x32_bf16 v[24:27], v[52:55], v[84:87], 0
    ds_read_b64 v[148:149], v3 offset:3136
    v_mfma_f32_16x16x32_bf16 v[24:27], v[48:51], v[88:91], v[24:27]
    ds_read_b64 v[150:151], v3 offset:3144
    v_mfma_f32_16x16x32_bf16 v[24:27], v[56:59], v[80:83], v[24:27]
    ds_read_b128 v[120:123], v2 offset:1088
    v_mfma_f32_16x16x32_bf16 v[28:31], v[52:55], v[88:91], 0
    ds_read_b64 v[152:153], v3 offset:2624
    v_mfma_f32_16x16x32_bf16 v[28:31], v[56:59], v[84:87], v[28:31]
    ds_read_b64 v[154:155], v3 offset:2632
    v_mfma_f32_16x16x32_bf16 v[32:35], v[56:59], v[88:91], 0
    ds_read_b128 v[124:127], v2 offset:1600
    v_mfma_f32_16x16x32_bf16 v[28:31], v[48:51], v[92:95], v[28:31]
    ds_read_b64 v[156:157], v3 offset:2112
    v_mfma_f32_16x16x32_bf16 v[28:31], v[60:63], v[80:83], v[28:31]
    ds_read_b64 v[158:159], v3 offset:2120
    v_mfma_f32_16x16x32_bf16 v[32:35], v[52:55], v[92:95], v[32:35]
    ds_read_b128 v[128:131], v2 offset:2112
    v_mfma_f32_16x16x32_bf16 v[32:35], v[60:63], v[84:87], v[32:35]
    ds_read_b64 v[160:161], v3 offset:1600
    v_mfma_f32_16x16x32_bf16 v[36:39], v[56:59], v[92:95], 0
    ds_read_b64 v[162:163], v3 offset:1608
    v_mfma_f32_16x16x32_bf16 v[36:39], v[60:63], v[88:91], v[36:39]
    ds_read_b128 v[132:135], v2 offset:2624
    v_mfma_f32_16x16x32_bf16 v[40:43], v[60:63], v[92:95], 0
    ds_read_b64 v[164:165], v3 offset:1088
    v_mfma_f32_16x16x32_bf16 v[32:35], v[48:51], v[96:99], v[32:35]
    ds_read_b64 v[166:167], v3 offset:1096
    v_mfma_f32_16x16x32_bf16 v[32:35], v[64:67], v[80:83], v[32:35]
    ds_read_b128 v[136:139], v2 offset:3136
    v_mfma_f32_16x16x32_bf16 v[36:39], v[52:55], v[96:99], v[36:39]
    ds_read_b64 v[168:169], v3 offset:576
    v_mfma_f32_16x16x32_bf16 v[36:39], v[64:67], v[84:87], v[36:39]
    ds_read_b64 v[170:171], v3 offset:584
    v_mfma_f32_16x16x32_bf16 v[40:43], v[56:59], v[96:99], v[40:43]
    ds_read_b128 v[140:143], v2 offset:3648
    v_mfma_f32_16x16x32_bf16 v[40:43], v[64:67], v[88:91], v[40:43]
    ds_read_b64 v[172:173], v3 offset:64
    v_mfma_f32_16x16x32_bf16 v[44:47], v[60:63], v[96:99], 0
    ds_read_b64 v[174:175], v3 offset:72
    v_mfma_f32_16x16x32_bf16 v[44:47], v[64:67], v[92:95], v[44:47]
    v_mfma_f32_16x16x32_bf16 v[36:39], v[48:51], v[100:103], v[36:39]
    v_mfma_f32_16x16x32_bf16 v[36:39], v[68:71], v[80:83], v[36:39]
    v_mfma_f32_16x16x32_bf16 v[40:43], v[52:55], v[100:103], v[40:43]
    v_mfma_f32_16x16x32_bf16 v[40:43], v[68:71], v[84:87], v[40:43]
    v_mfma_f32_16x16x32_bf16 v[44:47], v[56:59], v[100:103], v[44:47]
    v_mfma_f32_16x16x32_bf16 v[44:47], v[68:71], v[88:91], v[44:47]
    v_mfma_f32_16x16x32_bf16 v[40:43], v[48:51], v[104:107], v[40:43]
    v_mfma_f32_16x16x32_bf16 v[40:43], v[72:75], v[80:83], v[40:43]
    v_mfma_f32_16x16x32_bf16 v[44:47], v[52:55], v[104:107], v[44:47]
    v_mfma_f32_16x16x32_bf16 v[44:47], v[72:75], v[84:87], v[44:47]
    v_mfma_f32_16x16x32_bf16 v[44:47], v[48:51], v[108:111], v[44:47]
    v_mfma_f32_16x16x32_bf16 v[44:47], v[76:79], v[80:83], v[44:47]
    s_waitcnt vmcnt(0)
    ds_write_b32 v11, v251 offset:80
    s_mov_b32 s75, 0
poll_53:
    v_cmp_ne_u32 vcc, s70, v198
    v_cmp_ne_u32 s[46:47], s70, v199
    s_nop 0
    s_or_b64 vcc, vcc, s[46:47]
    s_cbranch_scc0 poll_ok_54
    s_add_u32 s75, s75, 1
    s_cmp_ge_u32 s75, 65536
    s_cbranch_scc1 poll_ok_54
    s_sleep 1
    buffer_load_dwordx2 v[198:199], v5, s[16:19], 0 offen sc1
    s_waitcnt vmcnt(0)
    s_branch poll_53
poll_ok_54:
    s_lshl_b32 s53, s68, 2
    s_add_u32 s53, s53, s64
    s_lshl_b32 s53, s53, 8
    s_add_u32 s53, s53, 0xa00000
    buffer_load_dwordx4 v[184:187], v15, s[16:19], s53 offen sc1
    buffer_load_dwordx4 v[188:191], v15, s[16:19], s53 offen offset:128 sc1
    s_waitcnt lgkmcnt(0)
    ds_read_b128 v[48:51], v2 offset:128
    v_mfma_f32_16x16x32_bf16 v[16:19], v[112:115], v[144:147], v[16:19]
    ds_read_b64 v[80:81], v3 offset:3712
    v_mfma_f32_16x16x32_bf16 v[20:23], v[112:115], v[148:151], v[20:23]
    ds_read_b64 v[82:83], v3 offset:3720
    v_mfma_f32_16x16x32_bf16 v[20:23], v[116:119], v[144:147], v[20:23]
    ds_read_b128 v[52:55], v2 offset:640
    v_mfma_f32_16x16x32_bf16 v[24:27], v[116:119], v[148:151], v[24:27]
    ds_read_b64 v[84:85], v3 offset:3200
    v_mfma_f32_16x16x32_bf16 v[24:27], v[112:115], v[152:155], v[24:27]
    ds_read_b64 v[86:87], v3 offset:3208
    v_mfma_f32_16x16x32_bf16 v[24:27], v[120:123], v[144:147], v[24:27]
    ds_read_b128 v[56:59], v2 offset:1152
    v_mfma_f32_16x16x32_bf16 v[28:31], v[116:119], v[152:155], v[28:31]
    ds_read_b64 v[88:89], v3 offset:2688
    v_mfma_f32_16x16x32_bf16 v[28:31], v[120:123], v[148:151], v[28:31]
    ds_read_b64 v[90:91], v3 offset:2696
    v_mfma_f32_16x16x32_bf16 v[32:35], v[120:123], v[152:155], v[32:35]
    ds_read_b128 v[60:63], v2 offset:1664
    v_mfma_f32_16x16x32_bf16 v[28:31], v[112:115], v[156:159], v[28:31]
    ds_read_b64 v[92:93], v3 offset:2176
    v_mfma_f32_16x16x32_bf16 v[28:31], v[124:127], v[144:147], v[28:31]
    ds_read_b64 v[94:95], v3 offset:2184
    v_mfma_f32_16x16x32_bf16 v[32:35], v[116:119], v[156:159], v[32:35]
    ds_read_b128 v[64:67], v2 offset:2176
    v_mfma_f32_16x16x32_bf16 v[32:35], v[124:127], v[148:151], v[32:35]
    ds_read_b64 v[96:97], v3 offset:1664
    v_mfma_f32_16x16x32_bf16 v[36:39], v[120:123], v[156:159], v[36:39]
    ds_read_b64 v[98:99], v3 offset:1672
    v_mfma_f32_16x16x32_bf16 v[36:39], v[124:127], v[152:155], v[36:39]
    ds_read_b128 v[68:71], v2 offset:2688
    v_mfma_f32_16x16x32_bf16 v[40:43], v[124:127], v[156:159], v[40:43]
    ds_read_b64 v[100:101], v3 offset:1152
    v_mfma_f32_16x16x32_bf16 v[32:35], v[112:115], v[160:163], v[32:35]
    ds_read_b64 v[102:103], v3 offset:1160
    v_mfma_f32_16x16x32_bf16 v[32:35], v[128:131], v[144:147], v[32:35]
    ds_read_b128 v[72:75], v2 offset:3200
    v_mfma_f32_16x16x32_bf16 v[36:39], v[116:119], v[160:163], v[36:39]
    ds_read_b64 v[104:105], v3 offset:640
    v_mfma_f32_16x16x32_bf16 v[36:39], v[128:131], v[148:151], v[36:39]
    ds_read_b64 v[106:107], v3 offset:648
    v_mfma_f32_16x16x32_bf16 v[40:43], v[120:123], v[160:163], v[40:43]
    ds_read_b128 v[76:79], v2 offset:3712
    v_mfma_f32_16x16x32_bf16 v[40:43], v[128:131], v[152:155], v[40:43]
    ds_read_b64 v[108:109], v3 offset:128
    v_mfma_f32_16x16x32_bf16 v[44:47], v[124:127], v[160:163], v[44:47]
    ds_read_b64 v[110:111], v3 offset:136
    v_mfma_f32_16x16x32_bf16 v[44:47], v[128:131], v[156:159], v[44:47]
    v_mfma_f32_16x16x32_bf16 v[36:39], v[112:115], v[164:167], v[36:39]
    v_mfma_f32_16x16x32_bf16 v[36:39], v[132:135], v[144:147], v[36:39]
    v_mfma_f32_16x16x32_bf16 v[40:43], v[116:119], v[164:167], v[40:43]
    v_mfma_f32_16x16x32_bf16 v[40:43], v[132:135], v[148:151], v[40:43]
    v_mfma_f32_16x16x32_bf16 v[44:47], v[120:123], v[164:167], v[44:47]
    v_mfma_f32_16x16x32_bf16 v[44:47], v[132:135], v[152:155], v[44:47]
    v_mfma_f32_16x16x32_bf16 v[40:43], v[112:115], v[168:171], v[40:43]
    v_mfma_f32_16x16x32_bf16 v[40:43], v[136:139], v[144:147], v[40:43]
    v_mfma_f32_16x16x32_bf16 v[44:47], v[116:119], v[168:171], v[44:47]
    v_mfma_f32_16x16x32_bf16 v[44:47], v[136:139], v[148:151], v[44:47]
    v_mfma_f32_16x16x32_bf16 v[44:47], v[112:115], v[172:175], v[44:47]
    v_mfma_f32_16x16x32_bf16 v[44:47], v[140:143], v[144:147], v[44:47]
    s_waitcnt lgkmcnt(0)
    ds_read_b128 v[112:115], v2 offset:192
    v_mfma_f32_16x16x32_bf16 v[16:19], v[48:51], v[80:83], v[16:19]
    ds_read_b64 v[144:145], v3 offset:3776
    v_mfma_f32_16x16x32_bf16 v[20:23], v[48:51], v[84:87], v[20:23]
    ds_read_b64 v[146:147], v3 offset:3784
    v_mfma_f32_16x16x32_bf16 v[20:23], v[52:55], v[80:83], v[20:23]
    ds_read_b128 v[116:119], v2 offset:704
    v_mfma_f32_16x16x32_bf16 v[24:27], v[52:55], v[84:87], v[24:27]
    ds_read_b64 v[148:149], v3 offset:3264
    v_mfma_f32_16x16x32_bf16 v[24:27], v[48:51], v[88:91], v[24:27]
    ds_read_b64 v[150:151], v3 offset:3272
    v_mfma_f32_16x16x32_bf16 v[24:27], v[56:59], v[80:83], v[24:27]
    ds_read_b128 v[120:123], v2 offset:1216
    v_mfma_f32_16x16x32_bf16 v[28:31], v[52:55], v[88:91], v[28:31]
    ds_read_b64 v[152:153], v3 offset:2752
    v_mfma_f32_16x16x32_bf16 v[28:31], v[56:59], v[84:87], v[28:31]
    ds_read_b64 v[154:155], v3 offset:2760
    v_mfma_f32_16x16x32_bf16 v[32:35], v[56:59], v[88:91], v[32:35]
    ds_read_b128 v[124:127], v2 offset:1728
    v_mfma_f32_16x16x32_bf16 v[28:31], v[48:51], v[92:95], v[28:31]
    ds_read_b64 v[156:157], v3 offset:2240
    v_mfma_f32_16x16x32_bf16 v[28:31], v[60:63], v[80:83], v[28:31]
    ds_read_b64 v[158:159], v3 offset:2248
    v_mfma_f32_16x16x32_bf16 v[32:35], v[52:55], v[92:95], v[32:35]
    ds_read_b128 v[128:131], v2 offset:2240
    v_mfma_f32_16x16x32_bf16 v[32:35], v[60:63], v[84:87], v[32:35]
    ds_read_b64 v[160:161], v3 offset:1728
    v_mfma_f32_16x16x32_bf16 v[36:39], v[56:59], v[92:95], v[36:39]
    ds_read_b64 v[162:163], v3 offset:1736
    v_mfma_f32_16x16x32_bf16 v[36:39], v[60:63], v[88:91], v[36:39]
    ds_read_b128 v[132:135], v2 offset:2752
    v_mfma_f32_16x16x32_bf16 v[40:43], v[60:63], v[92:95], v[40:43]
    ds_read_b64 v[164:165], v3 offset:1216
    v_mfma_f32_16x16x32_bf16 v[32:35], v[48:51], v[96:99], v[32:35]
    ds_read_b64 v[166:167], v3 offset:1224
    v_mfma_f32_16x16x32_bf16 v[32:35], v[64:67], v[80:83], v[32:35]
    ds_read_b128 v[136:139], v2 offset:3264
    v_mfma_f32_16x16x32_bf16 v[36:39], v[52:55], v[96:99], v[36:39]
    ds_read_b64 v[168:169], v3 offset:704
    v_mfma_f32_16x16x32_bf16 v[36:39], v[64:67], v[84:87], v[36:39]
    ds_read_b64 v[170:171], v3 offset:712
    v_mfma_f32_16x16x32_bf16 v[40:43], v[56:59], v[96:99], v[40:43]
    ds_read_b128 v[140:143], v2 offset:3776
    v_mfma_f32_16x16x32_bf16 v[40:43], v[64:67], v[88:91], v[40:43]
    ds_read_b64 v[172:173], v3 offset:192
    v_mfma_f32_16x16x32_bf16 v[44:47], v[60:63], v[96:99], v[44:47]
    ds_read_b64 v[174:175], v3 offset:200
    v_mfma_f32_16x16x32_bf16 v[44:47], v[64:67], v[92:95], v[44:47]
    v_mfma_f32_16x16x32_bf16 v[36:39], v[48:51], v[100:103], v[36:39]
    v_mfma_f32_16x16x32_bf16 v[36:39], v[68:71], v[80:83], v[36:39]
    v_mfma_f32_16x16x32_bf16 v[40:43], v[52:55], v[100:103], v[40:43]
    v_mfma_f32_16x16x32_bf16 v[40:43], v[68:71], v[84:87], v[40:43]
    v_mfma_f32_16x16x32_bf16 v[44:47], v[56:59], v[100:103], v[44:47]
    v_mfma_f32_16x16x32_bf16 v[44:47], v[68:71], v[88:91], v[44:47]
    v_mfma_f32_16x16x32_bf16 v[40:43], v[48:51], v[104:107], v[40:43]
    v_mfma_f32_16x16x32_bf16 v[40:43], v[72:75], v[80:83], v[40:43]
    v_mfma_f32_16x16x32_bf16 v[44:47], v[52:55], v[104:107], v[44:47]
    v_mfma_f32_16x16x32_bf16 v[44:47], v[72:75], v[84:87], v[44:47]
    v_mfma_f32_16x16x32_bf16 v[44:47], v[48:51], v[108:111], v[44:47]
    v_mfma_f32_16x16x32_bf16 v[44:47], v[76:79], v[80:83], v[44:47]
    s_waitcnt lgkmcnt(0)
    ds_read_b32 v48, v10 offset:768
    v_mfma_f32_16x16x32_bf16 v[16:19], v[112:115], v[144:147], v[16:19]
    ds_read_b32 v49, v10 offset:23552
    v_mfma_f32_16x16x32_bf16 v[20:23], v[112:115], v[148:151], v[20:23]
    ds_read_b32 v50, v10 offset:512
    v_mfma_f32_16x16x32_bf16 v[20:23], v[116:119], v[144:147], v[20:23]
    ds_read_b32 v51, v10 offset:23296
    v_mfma_f32_16x16x32_bf16 v[24:27], v[116:119], v[148:151], v[24:27]
    ds_read_b32 v52, v10 offset:256
    v_mfma_f32_16x16x32_bf16 v[24:27], v[112:115], v[152:155], v[24:27]
    ds_read_b32 v53, v10 offset:23040
    v_mfma_f32_16x16x32_bf16 v[24:27], v[120:123], v[144:147], v[24:27]
    ds_read_b32 v54, v10 offset:0
    v_mfma_f32_16x16x32_bf16 v[28:31], v[116:119], v[152:155], v[28:31]
    ds_read_b32 v55, v10 offset:22784
    v_mfma_f32_16x16x32_bf16 v[28:31], v[120:123], v[148:151], v[28:31]
    v_mfma_f32_16x16x32_bf16 v[32:35], v[120:123], v[152:155], v[32:35]
    v_mfma_f32_16x16x32_bf16 v[28:31], v[112:115], v[156:159], v[28:31]
    v_mfma_f32_16x16x32_bf16 v[28:31], v[124:127], v[144:147], v[28:31]
    v_mfma_f32_16x16x32_bf16 v[32:35], v[116:119], v[156:159], v[32:35]
    v_mfma_f32_16x16x32_bf16 v[32:35], v[124:127], v[148:151], v[32:35]
    v_mfma_f32_16x16x32_bf16 v[36:39], v[120:123], v[156:159], v[36:39]
    v_mfma_f32_16x16x32_bf16 v[36:39], v[124:127], v[152:155], v[36:39]
    v_mfma_f32_16x16x32_bf16 v[40:43], v[124:127], v[156:159], v[40:43]
    v_mfma_f32_16x16x32_bf16 v[32:35], v[112:115], v[160:163], v[32:35]
    v_mfma_f32_16x16x32_bf16 v[32:35], v[128:131], v[144:147], v[32:35]
    v_mfma_f32_16x16x32_bf16 v[36:39], v[116:119], v[160:163], v[36:39]
    v_mfma_f32_16x16x32_bf16 v[36:39], v[128:131], v[148:151], v[36:39]
    v_mfma_f32_16x16x32_bf16 v[40:43], v[120:123], v[160:163], v[40:43]
    v_mfma_f32_16x16x32_bf16 v[40:43], v[128:131], v[152:155], v[40:43]
    v_mfma_f32_16x16x32_bf16 v[44:47], v[124:127], v[160:163], v[44:47]
    v_mfma_f32_16x16x32_bf16 v[44:47], v[128:131], v[156:159], v[44:47]
    v_mfma_f32_16x16x32_bf16 v[36:39], v[112:115], v[164:167], v[36:39]
    v_mfma_f32_16x16x32_bf16 v[36:39], v[132:135], v[144:147], v[36:39]
    v_mfma_f32_16x16x32_bf16 v[40:43], v[116:119], v[164:167], v[40:43]
    v_mfma_f32_16x16x32_bf16 v[40:43], v[132:135], v[148:151], v[40:43]
    v_mfma_f32_16x16x32_bf16 v[44:47], v[120:123], v[164:167], v[44:47]
    v_mfma_f32_16x16x32_bf16 v[44:47], v[132:135], v[152:155], v[44:47]
    v_mfma_f32_16x16x32_bf16 v[40:43], v[112:115], v[168:171], v[40:43]
    v_mfma_f32_16x16x32_bf16 v[40:43], v[136:139], v[144:147], v[40:43]
    v_mfma_f32_16x16x32_bf16 v[44:47], v[116:119], v[168:171], v[44:47]
    v_mfma_f32_16x16x32_bf16 v[44:47], v[136:139], v[148:151], v[44:47]
    v_mfma_f32_16x16x32_bf16 v[44:47], v[112:115], v[172:175], v[44:47]
    v_mfma_f32_16x16x32_bf16 v[44:47], v[140:143], v[144:147], v[44:47]
    s_setprio 3
    s_add_u32 s72, s72, 4
    s_mov_b64 exec, 1
    ds_add_u32 v252, v253
    s_mov_b64 exec, -1
lw_55:
    ds_read_b32 v6, v252 offset:0
    s_waitcnt lgkmcnt(0)
    s_nop 0
    v_readfirstlane_b32 s53, v6
    s_nop 0
    s_cmp_ge_u32 s53, s72
    s_cbranch_scc1 lw_ok_56
    s_add_u32 s75, s75, 1
    s_cmp_lt_u32 s75, 4194304
    s_cbranch_scc1 lw_55
lw_ok_56:
    ds_write_b128 v8, v[16:19] offset:0
    ds_write_b128 v8, v[20:23] offset:1024
    ds_write_b128 v8, v[24:27] offset:2048
    ds_write_b128 v8, v[28:31] offset:3072
    ds_write_b128 v8, v[32:35] offset:4096
    ds_write_b128 v8, v[36:39] offset:5120
    ds_write_b128 v8, v[40:43] offset:6144
    ds_write_b128 v8, v[44:47] offset:7168
    s_add_u32 s72, s72, 4
    s_mov_b64 exec, 1
    ds_add_u32 v252, v253
    s_mov_b64 exec, -1
    s_lshl_b32 s100, s77, 16
    s_and_b32 s77, s77, 0xffff0000
    v_and_b32 v56, s76, v48
    v_lshlrev_b32 v57, 16, v48
    v_and_b32 v58, s76, v49
    v_lshlrev_b32 v59, 16, v49
    v_and_b32 v60, s76, v50
    v_lshlrev_b32 v61, 16, v50
    v_and_b32 v62, s76, v51
    v_lshlrev_b32 v63, 16, v51
    v_and_b32 v64, s76, v52
    v_lshlrev_b32 v65, 16, v52
    v_and_b32 v66, s76, v53
    v_lshlrev_b32 v67, 16, v53
    v_and_b32 v68, s76, v54
    v_lshlrev_b32 v69, 16, v54
    v_and_b32 v70, s76, v55
    v_lshlrev_b32 v71, 16, v55
    v_mul_f32 v56, s100, v56
    v_mul_f32 v57, s100, v57
    v_mul_f32 v58, s77, v58
    v_mul_f32 v59, s77, v59
    v_mov_b32 v145, s70
    v_mov_b32 v147, s70
    v_mul_f32 v60, s100, v60
    v_mul_f32 v61, s100, v61
    v_mul_f32 v62, s77, v62
    v_mul_f32 v63, s77, v63
    v_mov_b32 v149, s70
    v_mov_b32 v151, s70
    v_mul_f32 v64, s100, v64
    v_mul_f32 v65, s100, v65
    v_mul_f32 v66, s77, v66
    v_mul_f32 v67, s77, v67
    v_mov_b32 v153, s70
    v_mov_b32 v155, s70
    v_mul_f32 v68, s100, v68
    v_mul_f32 v69, s100, v69
    v_mul_f32 v70, s77, v70
    v_mul_f32 v71, s77, v71
    v_mov_b32 v157, s70
    v_mov_b32 v159, s70
lw_57:
    ds_read_b32 v6, v252 offset:0
    s_waitcnt lgkmcnt(0)
    s_nop 0
    v_readfirstlane_b32 s53, v6
    s_nop 0
    s_cmp_ge_u32 s53, s72
    s_cbranch_scc1 lw_ok_58
    s_add_u32 s75, s75, 1
    s_cmp_lt_u32 s75, 4194304
    s_cbranch_scc1 lw_57
lw_ok_58:
    ds_read_b64 v[112:113], v9 offset:0
    ds_read_b64 v[114:115], v9 offset:8192
    ds_read_b64 v[116:117], v9 offset:16384
    ds_read_b64 v[118:119], v9 offset:24576
    ds_read_b64 v[120:121], v9 offset:512
    ds_read_b64 v[122:123], v9 offset:8704
    ds_read_b64 v[124:125], v9 offset:16896
    ds_read_b64 v[126:127], v9 offset:25088
    ds_read_b64 v[128:129], v9 offset:1024
    ds_read_b64 v[130:131], v9 offset:9216
    ds_read_b64 v[132:133], v9 offset:17408
    ds_read_b64 v[134:135], v9 offset:25600
    ds_read_b64 v[136:137], v9 offset:1536
    ds_read_b64 v[138:139], v9 offset:9728
    ds_read_b64 v[140:141], v9 offset:17920
    ds_read_b64 v[142:143], v9 offset:26112
    s_waitcnt vmcnt(0)
    s_waitcnt lgkmcnt(12)
    v_add_f32 v56, v56, v112
    v_add_f32 v57, v57, v113
    v_add_f32 v58, v58, v116
    v_add_f32 v59, v59, v117
    v_add_f32 v56, v56, v114
    v_add_f32 v57, v57, v115
    v_add_f32 v58, v58, v118
    v_add_f32 v59, v59, v119
    v_cvt_pk_bf16_f32 v144, v56, v58
    v_cvt_pk_bf16_f32 v146, v57, v59
    buffer_store_dwordx4 v[144:147], v4, s[16:19], s73 offen offset:0 sc1
    s_waitcnt lgkmcnt(8)
    v_add_f32 v60, v60, v120
    v_add_f32 v61, v61, v121
    v_add_f32 v62, v62, v124
    v_add_f32 v63, v63, v125
    v_add_f32 v60, v60, v122
    v_add_f32 v61, v61, v123
    v_add_f32 v62, v62, v126
    v_add_f32 v63, v63, v127
    v_cvt_pk_bf16_f32 v148, v60, v62
    v_cvt_pk_bf16_f32 v150, v61, v63
    buffer_store_dwordx4 v[148:151], v4, s[16:19], s73 offen offset:1024 sc1
    s_waitcnt lgkmcnt(4)
    v_add_f32 v64, v64, v128
    v_add_f32 v65, v65, v129
    v_add_f32 v66, v66, v132
    v_add_f32 v67, v67, v133
    v_add_f32 v64, v64, v130
    v_add_f32 v65, v65, v131
    v_add_f32 v66, v66, v134
    v_add_f32 v67, v67, v135
    v_cvt_pk_bf16_f32 v152, v64, v66
    v_cvt_pk_bf16_f32 v154, v65, v67
    buffer_store_dwordx4 v[152:155], v4, s[16:19], s73 offen offset:2048 sc1
    s_waitcnt lgkmcnt(0)
    v_add_f32 v68, v68, v136
    v_add_f32 v69, v69, v137
    v_add_f32 v70, v70, v140
    v_add_f32 v71, v71, v141
    v_add_f32 v68, v68, v138
    v_add_f32 v69, v69, v139
    v_add_f32 v70, v70, v142
    v_add_f32 v71, v71, v143
    v_cvt_pk_bf16_f32 v156, v68, v70
    v_cvt_pk_bf16_f32 v158, v69, v71
    buffer_store_dwordx4 v[156:159], v4, s[16:19], s73 offen offset:3072 sc1
    v_mov_b32 v8, s70
    v_mov_b32 v9, 0
    s_mov_b64 exec, 1
    buffer_store_dword v8, v9, s[16:19], s74 offen sc1
    s_mov_b64 exec, -1
    s_lshl_b32 s53, s69, 2
    s_add_u32 s53, s53, s64
    s_lshr_b32 s54, s68, 3
    s_lshl_b32 s54, s54, 5
    s_add_u32 s54, s54, s53
    s_lshl_b32 s54, s54, 10
    s_add_u32 s54, s54, 0xac0000
    v_lshlrev_b32 v5, 7, v13
    v_add_u32 v5, s54, v5
    s_mul_i32 s53, s53, 133120
    s_lshl_b32 s54, s68, 9
    s_add_u32 s53, s53, s54
    s_add_u32 s73, s53, 0x1000000
    v_lshrrev_b32 v10, 5, v0
    v_mul_u32_u24 v8, 16128, v10
    v_add_u32 v8, v8, v4
    v_lshlrev_b32 v16, 16, v176
    v_and_b32 v17, s76, v176
    v_lshlrev_b32 v18, 16, v177
    v_and_b32 v19, s76, v177
    v_lshlrev_b32 v20, 16, v178
    v_and_b32 v21, s76, v178
    v_lshlrev_b32 v22, 16, v179
    v_and_b32 v23, s76, v179
    v_lshlrev_b32 v24, 16, v180
    v_and_b32 v25, s76, v180
    v_lshlrev_b32 v26, 16, v181
    v_and_b32 v27, s76, v181
    v_lshlrev_b32 v28, 16, v182
    v_and_b32 v29, s76, v182
    v_lshlrev_b32 v30, 16, v183
    v_and_b32 v31, s76, v183
    v_mov_b32 v96, 0
    v_mov_b32 v97, 0
    v_mov_b32 v98, 0
    v_mov_b32 v99, 0
    v_mov_b32 v100, 0
    v_mov_b32 v101, 0
    v_mov_b32 v102, 0
    v_mov_b32 v103, 0
    v_mov_b32 v104, 0
    v_mov_b32 v105, 0
    v_mov_b32 v106, 0
    v_mov_b32 v107, 0
    v_mov_b32 v108, 0
    v_mov_b32 v109, 0
    v_mov_b32 v110, 0
    v_mov_b32 v111, 0
    s_mul_i32 s53, s64, 544
    s_add_u32 s53, s53, 114688
    v_and_b32 v9, 3, v12
    v_mul_u32_u24 v9, 2176, v9
    v_lshl_add_u32 v9, v10, 6, v9
    v_lshl_add_u32 v9, v13, 3, v9
    v_add_u32 v9, s53, v9
    s_mul_i32 s53, s64, 2176
    s_add_u32 s53, s53, 114688
    v_mul_u32_u24 v7, 272, v13
    v_lshl_add_u32 v7, v12, 2, v7
    v_add_u32 v7, s53, v7
    s_lshl_b32 s53, s64, 14
    v_lshlrev_b32 v2, 1, v13
    v_xor_b32 v2, v2, v12
    v_lshlrev_b32 v2, 4, v2
    v_lshl_add_u32 v2, v12, 8, v2
    v_add_u32 v2, s53, v2
    v_xor_b32 v3, 16, v2
    v_mul_f32 v185, 0xbede652a, v185
    v_sub_f32 v72, v16, v184
    v_sub_f32 v73, v17, v184
    v_sub_f32 v74, v18, v184
    v_sub_f32 v75, v19, v184
    v_sub_f32 v76, v20, v184
    v_sub_f32 v77, v21, v184
    v_sub_f32 v78, v22, v184
    v_sub_f32 v79, v23, v184
    v_mul_f32 v72, v72, v185
    v_mul_f32 v73, v73, v185
    v_mul_f32 v74, v74, v185
    v_mul_f32 v75, v75, v185
    v_mul_f32 v76, v76, v185
    v_mul_f32 v77, v77, v185
    v_mul_f32 v78, v78, v185
    v_mul_f32 v79, v79, v185
    v_mul_f32 v189, 0xbede652a, v189
    v_sub_f32 v80, v24, v188
    v_sub_f32 v81, v25, v188
    v_sub_f32 v82, v26, v188
    v_sub_f32 v83, v27, v188
    v_sub_f32 v84, v28, v188
    v_sub_f32 v85, v29, v188
    v_sub_f32 v86, v30, v188
    v_sub_f32 v87, v31, v188
    v_mul_f32 v80, v80, v189
    v_mul_f32 v81, v81, v189
    v_mul_f32 v82, v82, v189
    v_mul_f32 v83, v83, v189
    v_mul_f32 v84, v84, v189
    v_mul_f32 v85, v85, v189
    v_mul_f32 v86, v86, v189
    v_mul_f32 v87, v87, v189
    s_setprio 0
lw_59:
    ds_read_b32 v6, v252 offset:96
    s_waitcnt lgkmcnt(0)
    s_nop 0
    v_readfirstlane_b32 s53, v6
    s_nop 0
    s_cmp_ge_u32 s53, 4
    s_cbranch_scc1 lw_ok_60
    s_sleep 2
    s_add_u32 s75, s75, 1
    s_cmp_lt_u32 s75, 4194304
    s_cbranch_scc1 lw_59
lw_ok_60:
    s_setprio 3
    s_mov_b32 s57, 0
yp_61:
    s_mov_b32 s54, s73
    buffer_load_dwordx4 v[160:163], v8, s[16:19], s54 offen sc1
    s_add_u32 s54, s54, 33280
    buffer_load_dwordx4 v[164:167], v8, s[16:19], s54 offen sc1
    s_add_u32 s54, s54, 33280
    buffer_load_dwordx4 v[168:171], v8, s[16:19], s54 offen sc1
    s_add_u32 s54, s54, 33280
    buffer_load_dwordx4 v[172:175], v8, s[16:19], s54 offen sc1
    s_waitcnt vmcnt(0)
    v_xor_b32 v48, s70, v161
    v_xor_b32 v52, s70, v163
    v_mov_b32 v161, v162
    v_xor_b32 v49, s70, v165
    v_xor_b32 v53, s70, v167
    v_mov_b32 v165, v166
    v_xor_b32 v50, s70, v169
    v_xor_b32 v54, s70, v171
    v_mov_b32 v169, v170
    v_xor_b32 v51, s70, v173
    v_xor_b32 v55, s70, v175
    v_mov_b32 v173, v174
    v_or3_b32 v48, v48, v49, v50
    v_or3_b32 v51, v51, v52, v53
    v_or3_b32 v48, v48, v54, v55
    v_or_b32 v48, v48, v51
    v_cmp_ne_u32 vcc, 0, v48
    s_cbranch_vccz yp_ok_62
    s_mov_b32 s75, 0
poll_63:
    buffer_load_dword v6, v5, s[16:19], 0 offen sc1
    s_waitcnt vmcnt(0)
    v_cmp_ne_u32 vcc, s70, v6
    s_cbranch_vccz poll_ok_64
    s_sleep 4
    s_add_u32 s75, s75, 1
    s_cmp_lt_u32 s75, 65536
    s_cbranch_scc1 poll_63
poll_ok_64:
    s_add_u32 s57, s57, s75
    s_add_u32 s57, s57, 1
    s_cmp_lt_u32 s57, 65536
    s_cbranch_scc1 yp_61
yp_ok_62:
    ds_write_b64 v9, v[160:161] offset:0
    ds_write_b64 v9, v[164:165] offset:128
    ds_write_b64 v9, v[168:169] offset:272
    ds_write_b64 v9, v[172:173] offset:400
    s_add_u32 s72, s72, 4
    s_mov_b64 exec, 1
    ds_add_u32 v252, v253
    s_mov_b64 exec, -1
lw_65:
    ds_read_b32 v6, v252 offset:0
    s_waitcnt lgkmcnt(0)
    s_nop 0
    v_readfirstlane_b32 s53, v6
    s_nop 0
    s_cmp_ge_u32 s53, s72
    s_cbranch_scc1 lw_ok_66
    s_add_u32 s75, s75, 1
    s_cmp_lt_u32 s75, 4194304
    s_cbranch_scc1 lw_65
lw_ok_66:
    ds_read_u16_d16_hi v96, v7 offset:0
    ds_read_u16_d16_hi v97, v7 offset:2
    ds_read_u16_d16_hi v98, v7 offset:64
    ds_read_u16_d16_hi v99, v7 offset:66
    ds_read_u16_d16_hi v100, v7 offset:128
    ds_read_u16_d16_hi v101, v7 offset:130
    ds_read_u16_d16_hi v102, v7 offset:192
    ds_read_u16_d16_hi v103, v7 offset:194
    ds_read_u16_d16_hi v104, v7 offset:32
    ds_read_u16_d16_hi v105, v7 offset:34
    ds_read_u16_d16_hi v106, v7 offset:96
    ds_read_u16_d16_hi v107, v7 offset:98
    ds_read_u16_d16_hi v108, v7 offset:160
    ds_read_u16_d16_hi v109, v7 offset:162
    ds_read_u16_d16_hi v110, v7 offset:224
    ds_read_u16_d16_hi v111, v7 offset:226
    s_waitcnt lgkmcnt(8)
    v_fmac_f32 v16, v72, v96
    v_fmac_f32 v17, v73, v97
    v_fmac_f32 v18, v74, v98
    v_fmac_f32 v19, v75, v99
    v_fmac_f32 v20, v76, v100
    v_fmac_f32 v21, v77, v101
    v_fmac_f32 v22, v78, v102
    v_fmac_f32 v23, v79, v103
    s_waitcnt lgkmcnt(0)
    v_fmac_f32 v24, v80, v104
    v_fmac_f32 v25, v81, v105
    v_fmac_f32 v26, v82, v106
    v_fmac_f32 v27, v83, v107
    v_fmac_f32 v28, v84, v108
    v_fmac_f32 v29, v85, v109
    v_fmac_f32 v30, v86, v110
    v_fmac_f32 v31, v87, v111
    s_barrier
    ds_read_b128 v[112:115], v2 offset:0
    ds_read_b128 v[116:119], v3 offset:0
    ds_read_b128 v[120:123], v2 offset:4096
    ds_read_b128 v[124:127], v3 offset:4096
    ds_read_b128 v[128:131], v2 offset:8192
    ds_read_b128 v[132:135], v3 offset:8192
    ds_read_b128 v[136:139], v2 offset:12288
    ds_read_b128 v[140:143], v3 offset:12288
    ds_read_b128 v[144:147], v2 offset:2048
    ds_read_b128 v[148:151], v3 offset:2048
    ds_read_b128 v[152:155], v2 offset:6144
    ds_read_b128 v[156:159], v3 offset:6144
    ds_read_b128 v[160:163], v2 offset:10240
    ds_read_b128 v[164:167], v3 offset:10240
    ds_read_b128 v[168:171], v2 offset:14336
    ds_read_b128 v[172:175], v3 offset:14336
    s_waitcnt lgkmcnt(8)
    v_pk_add_f32 v[112:113], v[112:113], v[120:121]
    v_pk_add_f32 v[114:115], v[114:115], v[122:123]
    v_pk_add_f32 v[116:117], v[116:117], v[124:125]
    v_pk_add_f32 v[118:119], v[118:119], v[126:127]
    v_pk_add_f32 v[128:129], v[128:129], v[136:137]
    v_pk_add_f32 v[130:131], v[130:131], v[138:139]
    v_pk_add_f32 v[132:133], v[132:133], v[140:141]
    v_pk_add_f32 v[134:135], v[134:135], v[142:143]
    v_pk_add_f32 v[112:113], v[112:113], v[16:17]
    v_pk_add_f32 v[114:115], v[114:115], v[18:19]
    v_pk_add_f32 v[116:117], v[116:117], v[20:21]
    v_pk_add_f32 v[118:119], v[118:119], v[22:23]
    v_pk_add_f32 v[112:113], v[112:113], v[128:129]
    v_pk_add_f32 v[114:115], v[114:115], v[130:131]
    v_pk_add_f32 v[116:117], v[116:117], v[132:133]
    v_pk_add_f32 v[118:119], v[118:119], v[134:135]
    v_cvt_pk_bf16_f32 v48, v112, v113
    v_cvt_pk_bf16_f32 v49, v114, v115
    v_cvt_pk_bf16_f32 v50, v116, v117
    v_cvt_pk_bf16_f32 v51, v118, v119
    buffer_store_dwordx4 v[48:51], v14, s[36:39], s60 offen
    s_waitcnt lgkmcnt(0)
    v_pk_add_f32 v[144:145], v[144:145], v[152:153]
    v_pk_add_f32 v[146:147], v[146:147], v[154:155]
    v_pk_add_f32 v[148:149], v[148:149], v[156:157]
    v_pk_add_f32 v[150:151], v[150:151], v[158:159]
    v_pk_add_f32 v[160:161], v[160:161], v[168:169]
    v_pk_add_f32 v[162:163], v[162:163], v[170:171]
    v_pk_add_f32 v[164:165], v[164:165], v[172:173]
    v_pk_add_f32 v[166:167], v[166:167], v[174:175]
    v_pk_add_f32 v[144:145], v[144:145], v[24:25]
    v_pk_add_f32 v[146:147], v[146:147], v[26:27]
    v_pk_add_f32 v[148:149], v[148:149], v[28:29]
    v_pk_add_f32 v[150:151], v[150:151], v[30:31]
    v_pk_add_f32 v[144:145], v[144:145], v[160:161]
    v_pk_add_f32 v[146:147], v[146:147], v[162:163]
    v_pk_add_f32 v[148:149], v[148:149], v[164:165]
    v_pk_add_f32 v[150:151], v[150:151], v[166:167]
    v_cvt_pk_bf16_f32 v52, v144, v145
    v_cvt_pk_bf16_f32 v53, v146, v147
    v_cvt_pk_bf16_f32 v54, v148, v149
    v_cvt_pk_bf16_f32 v55, v150, v151
    buffer_store_dwordx4 v[52:55], v14, s[36:39], s61 offen
    s_endpgm
g1_slow_4:
    s_waitcnt lgkmcnt(0)
    v_add_u32 v10, s58, v5
    v_mfma_f32_16x16x32_bf16 v[28:31], v[168:171], v[164:167], v[28:31]
    v_add_u32 v11, s58, v6
    v_mfma_f32_16x16x32_bf16 v[32:35], v[172:175], v[152:155], v[32:35]
    v_add_u32 v8, s58, v3
    v_mfma_f32_16x16x32_bf16 v[36:39], v[172:175], v[156:159], v[36:39]
    v_add_u32 v13, 1, v13
    v_mfma_f32_16x16x32_bf16 v[40:43], v[172:175], v[160:163], v[40:43]
    v_mfma_f32_16x16x32_bf16 v[44:47], v[172:175], v[164:167], v[44:47]
    v_mfma_f32_16x16x32_bf16 v[48:51], v[176:179], v[152:155], v[48:51]
    v_mfma_f32_16x16x32_bf16 v[52:55], v[176:179], v[156:159], v[52:55]
    v_mfma_f32_16x16x32_bf16 v[56:59], v[176:179], v[160:163], v[56:59]
    v_mfma_f32_16x16x32_bf16 v[60:63], v[176:179], v[164:167], v[60:63]
    v_mfma_f32_16x16x32_bf16 v[64:67], v[180:183], v[152:155], v[64:67]
    v_mfma_f32_16x16x32_bf16 v[68:71], v[180:183], v[156:159], v[68:71]
    v_mfma_f32_16x16x32_bf16 v[72:75], v[180:183], v[160:163], v[72:75]
    v_mfma_f32_16x16x32_bf16 v[76:79], v[180:183], v[164:167], v[76:79]
    s_cbranch_vccnz g1_skip_6
    v_mfma_f32_16x16x32_bf16 v[80:83], v[184:187], v[152:155], v[80:83]
    v_mfma_f32_16x16x32_bf16 v[84:87], v[184:187], v[156:159], v[84:87]
    v_mfma_f32_16x16x32_bf16 v[88:91], v[184:187], v[160:163], v[88:91]
    v_mfma_f32_16x16x32_bf16 v[92:95], v[184:187], v[164:167], v[92:95]
    v_mfma_f32_16x16x32_bf16 v[96:99], v[188:191], v[152:155], v[96:99]
    v_mfma_f32_16x16x32_bf16 v[100:103], v[188:191], v[156:159], v[100:103]
    v_mfma_f32_16x16x32_bf16 v[104:107], v[188:191], v[160:163], v[104:107]
    v_mfma_f32_16x16x32_bf16 v[108:111], v[188:191], v[164:167], v[108:111]
g1_skip_6:
lw_5007:
    ds_read_b32 v192, v193 offset:32
    s_waitcnt lgkmcnt(0)
    s_nop 0
    v_readfirstlane_b32 s53, v192
    s_nop 0
    s_cmp_ge_u32 s53, s55
    s_cbranch_scc1 lw_ok_5008
    s_add_u32 s75, s75, 1
    s_cmp_lt_u32 s75, 4194304
    s_cbranch_scc1 lw_5007
lw_ok_5008:
    ds_read_b128 v[112:115], v7 offset:0
    ds_read_b128 v[116:119], v7 offset:2048
    ds_read_b128 v[120:123], v7 offset:4096
    ds_read_b128 v[124:127], v7 offset:6144
    ds_read_b64_tr_b16 v[128:129], v9 offset:0
    ds_read_b64_tr_b16 v[130:131], v9 offset:256
    ds_read_b64_tr_b16 v[132:133], v9 offset:12288
    ds_read_b64_tr_b16 v[134:135], v9 offset:12544
    ds_read_b64_tr_b16 v[136:137], v10 offset:0
    ds_read_b64_tr_b16 v[138:139], v10 offset:256
    ds_read_b64_tr_b16 v[140:141], v10 offset:12288
    ds_read_b64_tr_b16 v[142:143], v10 offset:12544
    ds_read_b64_tr_b16 v[144:145], v11 offset:0
    ds_read_b64_tr_b16 v[146:147], v11 offset:256
    ds_read_b64_tr_b16 v[148:149], v11 offset:12288
    ds_read_b64_tr_b16 v[150:151], v11 offset:12544
    v_xor_b32 v193, 4, v193
    s_branch g1_loop
u_late_43:
    s_waitcnt vmcnt(0)
    ds_write_b128 v9, v[224:227]
    v_add_f32 v144, v144, v160
    v_add_f32 v145, v145, v161
    v_add_f32 v146, v146, v162
    v_add_f32 v147, v147, v163
    v_add_f32 v148, v148, v164
    v_add_f32 v149, v149, v165
    v_add_f32 v150, v150, v166
    v_add_f32 v151, v151, v167
    v_add_f32 v152, v152, v168
    v_add_f32 v153, v153, v169
    v_add_f32 v154, v154, v170
    v_add_f32 v155, v155, v171
    v_add_f32 v156, v156, v172
    v_add_f32 v157, v157, v173
    v_add_f32 v158, v158, v174
    v_add_f32 v159, v159, v175
    v_add_f32 v144, v144, v152
    v_add_f32 v145, v145, v153
    v_add_f32 v146, v146, v154
    v_add_f32 v147, v147, v155
    v_add_f32 v148, v148, v156
    v_add_f32 v149, v149, v157
    v_add_f32 v150, v150, v158
    v_add_f32 v151, v151, v159
    v_add_f32 v144, v144, v148
    v_add_f32 v145, v145, v149
    v_add_f32 v146, v146, v150
    v_add_f32 v147, v147, v151
    v_mov_b32 v148, v144
    v_mov_b32 v149, v145
    v_mov_b32 v150, v146
    v_mov_b32 v151, v147
    s_lshl_b32 s53, s65, 9
    s_add_u32 s53, s53, 135680
    v_and_b32 v8, 31, v0
    v_lshlrev_b32 v8, 4, v8
    v_add_u32 v8, s53, v8
    v_permlane32_swap_b32 v144, v148
    v_permlane32_swap_b32 v145, v149
    v_permlane32_swap_b32 v146, v150
    v_permlane32_swap_b32 v147, v151
    s_nop 0
    v_add_f32 v144, v144, v148
    v_add_f32 v145, v145, v149
    v_add_f32 v146, v146, v150
    v_add_f32 v147, v147, v151
    ds_write_b128 v8, v[144:147]
    s_mov_b64 exec, 1
    ds_add_u32 v252, v253 offset:8
    s_mov_b64 exec, -1
    s_mov_b32 s75, 0
poll_45:
    v_cmp_ne_u32 vcc, s70, v18
    v_cmp_ne_u32 s[46:47], s70, v19
    s_nop 0
    s_or_b64 vcc, vcc, s[46:47]
    s_cbranch_scc0 poll_ok_46
    s_add_u32 s75, s75, 1
    s_cmp_ge_u32 s75, 65536
    s_cbranch_scc1 poll_ok_46
    s_sleep 1
    buffer_load_dwordx2 v[18:19], v16, s[16:19], 0 offen sc1
    s_waitcnt vmcnt(0)
    s_branch poll_45
poll_ok_46:
    s_add_u32 s55, s73, 0x600000
    buffer_load_dwordx4 v[128:131], v4, s[16:19], s55 offen offset:0 sc1
    buffer_load_dwordx4 v[132:135], v4, s[16:19], s55 offen offset:1024 sc1
    buffer_load_dwordx4 v[136:139], v4, s[16:19], s55 offen offset:2048 sc1
    buffer_load_dwordx4 v[140:143], v4, s[16:19], s55 offen offset:3072 sc1
    s_branch u_join_44
L_end:
    s_endpgm
.section .rodata,"a"
.p2align 6
.amdhsa_kernel parallel_sum__ssm_conv_h3__geglu_ffn__prompt_kernel
  .amdhsa_next_free_vgpr 256
  .amdhsa_next_free_sgpr 102
  .amdhsa_accum_offset 256
  .amdhsa_group_segment_fixed_size 0
  .amdhsa_kernarg_size 104
  .amdhsa_user_sgpr_count 2
  .amdhsa_user_sgpr_kernarg_segment_ptr 1
  .amdhsa_system_sgpr_workgroup_id_x 1
.end_amdhsa_kernel
```
